```python
import torch

def _softmax(x, axis=-1):
    return torch.softmax(x, dim=axis)

def _gelu(x):
    return torch.nn.functional.gelu(x, approximate='tanh')

def _silu(x):
    return torch.nn.functional.silu(x)

def _sigmoid(x):
    return torch.sigmoid(x)

def _layernorm(x, axis=-1, eps=1e-05):
    m = x.mean(dim=axis, keepdim=True)
    v = x.var(dim=axis, keepdim=True, unbiased=False)
    return (x - m) / torch.sqrt(v + eps)

def _scatter_add(tgt, idx, src, axis=0):
    return tgt.clone().index_add_(axis, idx, src)

def _segment_sum(src, seg, n):
    out = torch.zeros((n,) + src.shape[1:], dtype=src.dtype)
    return out.index_add_(0, seg, src)

def _pad(x, pw):
    flat = tuple((v for pair in reversed(pw) for v in pair))
    return torch.nn.functional.pad(x, flat)
kernel_name = 'standalone__pixart__diffusion'

def setup_inputs():

    _w = lambda a: (lambda t: t.to(torch.bfloat16) if t.is_floating_point() else t)(torch.as_tensor(a))
    B, N, D, M = (2, 256, 1152, 77)
    return {'x': _w((lambda *s: torch.randn(*s, dtype=torch.bfloat16) * 0.05)(B, N, D)), 'c': _w((lambda *s: torch.randn(*s, dtype=torch.bfloat16) * 0.05)(B, D)), 'y': _w((lambda *s: torch.randn(*s, dtype=torch.bfloat16) * 0.1)(B, M, D)), 'wqkv': _w((lambda *s: torch.randn(*s, dtype=torch.bfloat16) * 0.05)(D, 3 * D)), 'wo': _w((lambda *s: torch.randn(*s, dtype=torch.bfloat16) * 0.05)(D, D)), 'wq_c': _w((lambda *s: torch.randn(*s, dtype=torch.bfloat16) * 0.1)(D, D)), 'wkv_c': _w((lambda *s: torch.randn(*s, dtype=torch.bfloat16) * 0.1)(D, 2 * D)), 'wo_c': _w((lambda *s: torch.randn(*s, dtype=torch.bfloat16) * 0.05)(D, D)), 'w_mod': _w((lambda *s: torch.randn(*s, dtype=torch.bfloat16) * 0.05)(D, 6 * D))}

def reference(x, c, y, wqkv, wo, wq_c, wkv_c, wo_c, w_mod):
    B, N, D = x.shape
    mod = (_silu(c) @ w_mod).reshape(B, 6, 1, D)
    shift_a, scale_a, gate_a, shift_m, scale_m, gate_m = [mod[:, i] for i in range(6)]
    h = _layernorm(x, axis=-1) * (1 + scale_a) + shift_a
    qkv = h @ wqkv
    q, k, v = (qkv[..., :D].clone(), qkv[..., D:2 * D].clone(), qkv[..., 2 * D:].clone())
    p = _softmax(torch.einsum('bqd,bkd->bqk', q, k) * D ** (-0.5), axis=-1)
    x = x + gate_a * (torch.einsum('bqk,bkd->bqd', p, v) @ wo)
    hc = _layernorm(x, axis=-1)
    qc = hc @ wq_c
    kvc = y @ wkv_c
    kc, vc = (kvc[..., :D].clone(), kvc[..., D:].clone())
    pc = _softmax(torch.einsum('bqd,bkd->bqk', qc, kc) * D ** (-0.5), axis=-1)
    return x + torch.einsum('bqk,bkd->bqd', pc, vc) @ wo_c
```

```asm
; @launch grid=(256,1,1) block=(512,1,1) lds=147456
.amdgcn_target "amdgcn-amd-amdhsa--gfx950"
.text
    .globl standalone__pixart__diffusion_kernel
    .p2align 8
    .type standalone__pixart__diffusion_kernel,@function
standalone__pixart__diffusion_kernel:
    s_cmp_ge_u32 s2, 256
    s_cbranch_scc1 standalone__pixart__diffusion_kernel_end
    s_load_dwordx16 s[16:31], s[0:1], 0
    s_load_dwordx8 s[32:39], s[0:1], 64
    v_lshrrev_b32 v5, 6, v0
    v_and_b32 v1, 63, v0
    s_and_b32 s4, s2, 7
    v_readfirstlane_b32 s6, v5
    s_lshr_b32 s5, s2, 3
    v_and_b32 v2, 15, v0
    v_bfe_u32 v3, v0, 4, 2
    v_lshlrev_b32 v4, 5, v2
    v_lshl_add_u32 v4, v3, 3, v4
    v_lshlrev_b32 v5, 4, v1
    s_mov_b32 s93, -1
    s_mov_b32 s100, 32
    s_mul_i32 s101, s4, 8
    s_and_b32 s8, s5, 7
    s_add_u32 s101, s101, s8
    s_mul_i32 s101, s101, 2304
    s_waitcnt lgkmcnt(0)
    s_add_u32 s56, s38, 8716288
    s_addc_u32 s57, s39, 0
    s_mov_b32 s58, 196608
    s_mov_b32 s59, 0x20000
    s_add_u32 s94, s38, 7790592
    s_addc_u32 s95, s39, 0
    s_load_dword s3, s[94:95], 0
    s_cmp_lt_u32 s5, 6
    s_cbranch_scc1 k1_spare
    s_cmp_ge_u32 s5, 28
    s_cbranch_scc1 k1_rows
    s_cmp_ge_u32 s5, 14
    s_cbranch_scc1 k1_prod
    s_sub_u32 s7, s5, 6
    s_lshr_b32 s9, s7, 2
    s_lshl_b32 s8, s4, 1
    s_add_u32 s9, s9, s8
    s_bfe_u32 s8, s7, 0x10001
    s_mul_i32 s10, s8, 73728
    s_lshl_b32 s11, s9, 3
    s_add_u32 s10, s10, s11
    s_and_b32 s11, s7, 1
    s_lshl_b32 s11, s11, 2
    s_add_u32 s10, s10, s11
    s_add_u32 s93, s10, 512
    s_bitcmp1_b32 s7, 0
    s_cbranch_scc1 k1_kv48
    s_mov_b32 s40, s20
    s_mov_b32 s41, s21
    s_mov_b32 s42, 354816
    s_mov_b32 s43, 0x20000
    s_mov_b32 s44, s28
    s_mov_b32 s45, s29
    s_mov_b32 s46, 5308416
    s_mov_b32 s47, 0x20000
    s_add_u32 s48, s38, 4718592
    s_addc_u32 s49, s39, 0
    s_mov_b32 s50, 737280
    s_mov_b32 s51, 0x20000
    s_mul_i32 s10, s8, 177408
    s_lshl_b32 s11, s9, 7
    s_mul_i32 s12, s9, 20480
    s_mul_i32 s13, s8, 2560
    s_add_u32 s12, s12, s13
    s_cmp_lt_u32 s6, 4
    s_cbranch_scc1 Lcomp_1
    s_sub_u32 s74, s6, 4
    s_lshl_b32 s68, s74, 3
    v_lshrrev_b32 v6, 3, v1
    v_add_u32 v6, s68, v6
    v_and_b32 v7, 7, v1
    v_and_b32 v8, 2, v6
    v_bfe_u32 v9, v6, 3, 1
    v_lshl_or_b32 v8, v9, 2, v8
    v_xor_b32 v7, v7, v8
    s_movk_i32 s68, 4608
    v_mul_u32_u24 v6, s68, v6
    v_lshl_add_u32 v10, v7, 4, v6
    v_add_u32 v10, s11, v10
    v_add_u32 v11, 147456, v10
    s_mul_i32 s68, s74, 8
    v_lshrrev_b32 v6, 3, v1
    v_add_u32 v6, s68, v6
    v_and_b32 v7, 7, v1
    v_add_u32 v8, 0, v6
    v_bfe_u32 v9, v8, 1, 3
    v_xor_b32 v9, v9, v7
    s_movk_i32 s68, 2304
    v_mul_u32_u24 v8, s68, v8
    v_lshl_add_u32 v12, v9, 4, v8
    v_add_u32 v12, s10, v12
    s_mul_i32 s65, s74, 1024
    s_mul_i32 s66, s74, 1024
    s_add_u32 s66, s66, 4096
    s_mov_b32 s61, 0
    s_mov_b32 s62, 0
    s_add_u32 s67, s65, 61440
    s_mov_b32 s60, 0
Lpr_4:
    s_mov_b32 m0, s66
    s_nop 0
    buffer_load_dwordx4 v10, s[44:47], s62 offen lds
    s_add_u32 m0, s66, 4096
    s_nop 0
    buffer_load_dwordx4 v11, s[44:47], s62 offen lds
    s_mov_b32 m0, s65
    s_nop 0
    buffer_load_dwordx4 v12, s[40:43], s61 offen lds
    s_add_u32 s61, s61, 128
    s_add_u32 s65, s65, 12288
    s_add_u32 s62, s62, 294912
    s_add_u32 s66, s66, 12288
    s_add_u32 s60, s60, 1
    s_cmp_lt_u32 s60, 4
    s_cbranch_scc1 Lpr_4
Lld_2:
    s_waitcnt vmcnt(9)
Llsk_3:
    s_barrier
    s_mov_b32 m0, s66
    s_nop 0
    buffer_load_dwordx4 v10, s[44:47], s62 offen lds
    s_add_u32 m0, s66, 4096
    s_nop 0
    buffer_load_dwordx4 v11, s[44:47], s62 offen lds
    s_mov_b32 m0, s65
    s_nop 0
    buffer_load_dwordx4 v12, s[40:43], s61 offen lds
    s_add_u32 s61, s61, 128
    s_add_u32 s65, s65, 12288
    s_add_u32 s62, s62, 294912
    s_add_u32 s66, s66, 12288
    s_cmp_eq_u32 s65, s67
    s_cselect_b32 s68, 61440, 0
    s_sub_u32 s65, s65, s68
    s_sub_u32 s66, s66, s68
    s_add_u32 s60, s60, 1
    s_cmp_lt_u32 s60, 18
    s_cbranch_scc1 Lld_2
    s_waitcnt vmcnt(9)
    s_barrier
    s_waitcnt vmcnt(6)
    s_barrier
    s_waitcnt vmcnt(3)
    s_barrier
    s_waitcnt vmcnt(0)
    s_barrier
    s_barrier
    s_branch ph1_fin
Lcomp_1:
    s_mov_b32 s70, 0
    s_and_b32 s71, s6, 3
    v_bfe_u32 v6, v2, 1, 3
    v_xor_b32 v6, v6, v3
    v_lshlrev_b32 v6, 4, v6
    v_lshl_add_u32 v6, v2, 7, v6
    s_mul_i32 s72, s70, 4096
    s_add_u32 s72, s72, 0
    v_add_u32 v10, s72, v6
    v_xor_b32 v11, 64, v10
    v_lshrrev_b32 v6, 2, v2
    v_lshl_add_u32 v7, v3, 3, v6
    v_lshlrev_b32 v7, 7, v7
    v_and_b32 v8, 1, v2
    v_lshl_add_u32 v7, v8, 3, v7
    v_add_u32 v7, 4096, v7
    v_and_b32 v8, 1, v3
    v_lshrrev_b32 v9, 3, v2
    v_lshl_or_b32 v8, v8, 1, v9
    v_lshlrev_b32 v8, 1, v8
    v_bfe_u32 v9, v2, 1, 1
    v_or_b32 v8, v8, v9
    s_mul_i32 s72, s71, 2
    s_add_u32 s72, s72, 0
    v_xor_b32 v9, s72, v8
    v_lshl_add_u32 v14, v9, 4, v7
    v_mov_b32 v16, 0
    v_mov_b32 v17, 0
    v_mov_b32 v18, 0
    v_mov_b32 v19, 0
    v_mov_b32 v20, 0
    v_mov_b32 v21, 0
    v_mov_b32 v22, 0
    v_mov_b32 v23, 0
    s_mov_b32 s60, 0
    s_mov_b32 s64, 0
    v_add_u32 v12, s64, v10
    v_add_u32 v13, s64, v11
    v_add_u32 v15, s64, v14
    s_barrier
    ds_read_b128 v[24:27], v12 offset:0
    ds_read_b64_tr_b16 v[40:41], v15 offset:0
    ds_read_b64_tr_b16 v[42:43], v15 offset:512
    ds_read_b128 v[28:31], v12 offset:2048
Lk_5:
    s_add_u32 s64, s64, 12288
    s_cmp_eq_u32 s64, 61440
    s_cselect_b32 s64, 0, s64
    s_add_u32 s60, s60, 1
    s_waitcnt lgkmcnt(0)
    v_mfma_f32_16x16x32_bf16 v[16:19], v[40:43], v[24:27], v[16:19]
    ds_read_b128 v[32:35], v13 offset:0
    ds_read_b64_tr_b16 v[44:45], v15 offset:4096
    v_mfma_f32_16x16x32_bf16 v[20:23], v[40:43], v[28:31], v[20:23]
    ds_read_b64_tr_b16 v[46:47], v15 offset:4608
    ds_read_b128 v[36:39], v13 offset:2048
    v_add_u32 v12, s64, v10
    v_add_u32 v13, s64, v11
    v_add_u32 v15, s64, v14
    s_cmp_lt_u32 s60, 18
    s_waitcnt lgkmcnt(0)
    s_barrier
    v_mfma_f32_16x16x32_bf16 v[16:19], v[44:47], v[32:35], v[16:19]
    ds_read_b128 v[24:27], v12 offset:0
    ds_read_b64_tr_b16 v[40:41], v15 offset:0
    v_mfma_f32_16x16x32_bf16 v[20:23], v[44:47], v[36:39], v[20:23]
    ds_read_b64_tr_b16 v[42:43], v15 offset:512
    ds_read_b128 v[28:31], v12 offset:2048
    s_cbranch_scc1 Lk_5
    s_waitcnt lgkmcnt(0)
    s_nop 6
    s_mul_i32 s72, s70, 1024
    s_mul_i32 s73, s71, 5120
    s_add_u32 s72, s72, s73
    s_add_u32 s72, s72, s12
    v_cvt_pk_bf16_f32 v16, v16, v17
    v_cvt_pk_bf16_f32 v17, v18, v19
    buffer_store_dwordx2 v[16:17], v4, s[48:51], s72 offen offset:0 sc1
    v_cvt_pk_bf16_f32 v20, v20, v21
    v_cvt_pk_bf16_f32 v21, v22, v23
    buffer_store_dwordx2 v[20:21], v4, s[48:51], s72 offen offset:512 sc1
    s_branch ph1_fin
k1_kv48:
    s_mov_b32 s40, s20
    s_mov_b32 s41, s21
    s_mov_b32 s42, 354816
    s_mov_b32 s43, 0x20000
    s_mov_b32 s44, s28
    s_mov_b32 s45, s29
    s_mov_b32 s46, 5308416
    s_mov_b32 s47, 0x20000
    s_add_u32 s48, s38, 4718592
    s_addc_u32 s49, s39, 0
    s_mov_b32 s50, 737280
    s_mov_b32 s51, 0x20000
    s_mul_i32 s10, s8, 177408
    s_lshl_b32 s11, s9, 7
    s_mul_i32 s12, s9, 20480
    s_mul_i32 s13, s8, 2560
    s_add_u32 s12, s12, s13
    s_add_u32 s10, s10, 73728
    s_add_u32 s12, s12, 1024
    s_cmp_lt_u32 s6, 4
    s_cbranch_scc1 Lcomp_6
    s_sub_u32 s74, s6, 4
    s_lshl_b32 s68, s74, 3
    v_lshrrev_b32 v6, 3, v1
    v_add_u32 v6, s68, v6
    v_and_b32 v7, 7, v1
    v_and_b32 v8, 2, v6
    v_bfe_u32 v9, v6, 3, 1
    v_lshl_or_b32 v8, v9, 2, v8
    v_xor_b32 v7, v7, v8
    s_movk_i32 s68, 4608
    v_mul_u32_u24 v6, s68, v6
    v_lshl_add_u32 v10, v7, 4, v6
    v_add_u32 v10, s11, v10
    v_add_u32 v11, 147456, v10
    s_mul_i32 s68, s74, 12
    v_lshrrev_b32 v6, 3, v1
    v_add_u32 v6, s68, v6
    v_and_b32 v7, 7, v1
    v_add_u32 v8, 0, v6
    v_bfe_u32 v9, v8, 1, 3
    v_xor_b32 v9, v9, v7
    s_movk_i32 s68, 2304
    v_mul_u32_u24 v8, s68, v8
    v_lshl_add_u32 v12, v9, 4, v8
    v_add_u32 v12, s10, v12
    v_add_u32 v8, 8, v6
    v_bfe_u32 v9, v8, 1, 3
    v_xor_b32 v9, v9, v7
    s_movk_i32 s68, 2304
    v_mul_u32_u24 v8, s68, v8
    v_lshl_add_u32 v13, v9, 4, v8
    v_add_u32 v13, s10, v13
    s_mul_i32 s65, s74, 1536
    s_mul_i32 s66, s74, 1024
    s_add_u32 s66, s66, 6144
    s_mov_b32 s61, 0
    s_mov_b32 s62, 0
    s_add_u32 s67, s65, 71680
    s_mov_b32 s60, 0
Lpr_9:
    s_mov_b32 m0, s66
    s_nop 0
    buffer_load_dwordx4 v10, s[44:47], s62 offen lds
    s_add_u32 m0, s66, 4096
    s_nop 0
    buffer_load_dwordx4 v11, s[44:47], s62 offen lds
    s_mov_b32 m0, s65
    s_nop 0
    buffer_load_dwordx4 v12, s[40:43], s61 offen lds
    s_add_u32 m0, s65, 1024
    s_mov_b32 exec_hi, 0
    buffer_load_dwordx4 v13, s[40:43], s61 offen lds
    s_mov_b32 exec_hi, -1
    s_add_u32 s61, s61, 128
    s_add_u32 s65, s65, 14336
    s_add_u32 s62, s62, 294912
    s_add_u32 s66, s66, 14336
    s_add_u32 s60, s60, 1
    s_cmp_lt_u32 s60, 4
    s_cbranch_scc1 Lpr_9
Lld_7:
    s_waitcnt vmcnt(12)
Llsk_8:
    s_barrier
    s_mov_b32 m0, s66
    s_nop 0
    buffer_load_dwordx4 v10, s[44:47], s62 offen lds
    s_add_u32 m0, s66, 4096
    s_nop 0
    buffer_load_dwordx4 v11, s[44:47], s62 offen lds
    s_mov_b32 m0, s65
    s_nop 0
    buffer_load_dwordx4 v12, s[40:43], s61 offen lds
    s_add_u32 m0, s65, 1024
    s_mov_b32 exec_hi, 0
    buffer_load_dwordx4 v13, s[40:43], s61 offen lds
    s_mov_b32 exec_hi, -1
    s_add_u32 s61, s61, 128
    s_add_u32 s65, s65, 14336
    s_add_u32 s62, s62, 294912
    s_add_u32 s66, s66, 14336
    s_cmp_eq_u32 s65, s67
    s_cselect_b32 s68, 71680, 0
    s_sub_u32 s65, s65, s68
    s_sub_u32 s66, s66, s68
    s_add_u32 s60, s60, 1
    s_cmp_lt_u32 s60, 18
    s_cbranch_scc1 Lld_7
    s_waitcnt vmcnt(12)
    s_barrier
    s_waitcnt vmcnt(8)
    s_barrier
    s_waitcnt vmcnt(4)
    s_barrier
    s_waitcnt vmcnt(0)
    s_barrier
    s_barrier
    s_branch ph1_fin
Lcomp_6:
    s_mov_b32 s70, 0
    s_and_b32 s71, s6, 3
    v_bfe_u32 v6, v2, 1, 3
    v_xor_b32 v6, v6, v3
    v_lshlrev_b32 v6, 4, v6
    v_lshl_add_u32 v6, v2, 7, v6
    s_mul_i32 s72, s70, 6144
    s_add_u32 s72, s72, 0
    v_add_u32 v10, s72, v6
    v_xor_b32 v11, 64, v10
    v_lshrrev_b32 v6, 2, v2
    v_lshl_add_u32 v7, v3, 3, v6
    v_lshlrev_b32 v7, 7, v7
    v_and_b32 v8, 1, v2
    v_lshl_add_u32 v7, v8, 3, v7
    v_add_u32 v7, 6144, v7
    v_and_b32 v8, 1, v3
    v_lshrrev_b32 v9, 3, v2
    v_lshl_or_b32 v8, v8, 1, v9
    v_lshlrev_b32 v8, 1, v8
    v_bfe_u32 v9, v2, 1, 1
    v_or_b32 v8, v8, v9
    s_mul_i32 s72, s71, 2
    s_add_u32 s72, s72, 0
    v_xor_b32 v9, s72, v8
    v_lshl_add_u32 v14, v9, 4, v7
    v_mov_b32 v16, 0
    v_mov_b32 v17, 0
    v_mov_b32 v18, 0
    v_mov_b32 v19, 0
    v_mov_b32 v20, 0
    v_mov_b32 v21, 0
    v_mov_b32 v22, 0
    v_mov_b32 v23, 0
    v_mov_b32 v24, 0
    v_mov_b32 v25, 0
    v_mov_b32 v26, 0
    v_mov_b32 v27, 0
    s_mov_b32 s60, 0
    s_mov_b32 s64, 0
    v_add_u32 v12, s64, v10
    v_add_u32 v13, s64, v11
    v_add_u32 v15, s64, v14
    s_barrier
    ds_read_b128 v[28:31], v12 offset:0
    ds_read_b64_tr_b16 v[52:53], v15 offset:0
    ds_read_b64_tr_b16 v[54:55], v15 offset:512
    ds_read_b128 v[32:35], v12 offset:2048
    ds_read_b128 v[36:39], v12 offset:4096
Lk_10:
    s_add_u32 s64, s64, 14336
    s_cmp_eq_u32 s64, 71680
    s_cselect_b32 s64, 0, s64
    s_add_u32 s60, s60, 1
    s_waitcnt lgkmcnt(0)
    v_mfma_f32_16x16x32_bf16 v[16:19], v[52:55], v[28:31], v[16:19]
    ds_read_b128 v[40:43], v13 offset:0
    ds_read_b64_tr_b16 v[56:57], v15 offset:4096
    v_mfma_f32_16x16x32_bf16 v[20:23], v[52:55], v[32:35], v[20:23]
    ds_read_b64_tr_b16 v[58:59], v15 offset:4608
    ds_read_b128 v[44:47], v13 offset:2048
    v_mfma_f32_16x16x32_bf16 v[24:27], v[52:55], v[36:39], v[24:27]
    ds_read_b128 v[48:51], v13 offset:4096
    v_add_u32 v12, s64, v10
    v_add_u32 v13, s64, v11
    v_add_u32 v15, s64, v14
    s_cmp_lt_u32 s60, 18
    s_waitcnt lgkmcnt(0)
    s_barrier
    v_mfma_f32_16x16x32_bf16 v[16:19], v[56:59], v[40:43], v[16:19]
    ds_read_b128 v[28:31], v12 offset:0
    ds_read_b64_tr_b16 v[52:53], v15 offset:0
    v_mfma_f32_16x16x32_bf16 v[20:23], v[56:59], v[44:47], v[20:23]
    ds_read_b64_tr_b16 v[54:55], v15 offset:512
    ds_read_b128 v[32:35], v12 offset:2048
    v_mfma_f32_16x16x32_bf16 v[24:27], v[56:59], v[48:51], v[24:27]
    ds_read_b128 v[36:39], v12 offset:4096
    s_cbranch_scc1 Lk_10
    s_waitcnt lgkmcnt(0)
    s_nop 6
    s_mul_i32 s72, s70, 1536
    s_mul_i32 s73, s71, 5120
    s_add_u32 s72, s72, s73
    s_add_u32 s72, s72, s12
    v_cvt_pk_bf16_f32 v16, v16, v17
    v_cvt_pk_bf16_f32 v17, v18, v19
    buffer_store_dwordx2 v[16:17], v4, s[48:51], s72 offen offset:0 sc1
    v_cvt_pk_bf16_f32 v20, v20, v21
    v_cvt_pk_bf16_f32 v21, v22, v23
    buffer_store_dwordx2 v[20:21], v4, s[48:51], s72 offen offset:512 sc1
    v_cvt_pk_bf16_f32 v24, v24, v25
    v_cvt_pk_bf16_f32 v25, v26, v27
    buffer_store_dwordx2 v[24:25], v4, s[48:51], s72 offen offset:1024 sc1
    s_branch ph1_fin
k1_prod:
    s_sub_u32 s8, s5, 14
    s_lshl_b32 s7, s8, 3
    s_add_u32 s7, s7, s4
    s_cmp_ge_u32 s6, 6
    s_cbranch_scc1 Lpub_11
    s_mul_i32 s12, s8, 6
    s_add_u32 s12, s12, s6
    s_mul_i32 s13, s7, 6
    s_add_u32 s13, s13, s6
    s_cmp_ge_u32 s7, 108
    s_cbranch_scc1 Lppf_12
    s_mov_b32 s40, s32
    s_mov_b32 s41, s33
    s_mov_b32 s42, 15925248
    s_mov_b32 s43, 0x20000
    s_mov_b32 s44, s18
    s_mov_b32 s45, s19
    s_mov_b32 s46, 4608
    s_mov_b32 s47, 0x20000
    s_and_b32 s9, s7, 1
    s_mul_i32 s9, s9, 576
    s_mul_i32 s10, s6, 96
    s_add_u32 s9, s9, s10
    v_and_b32 v9, 1, v2
    v_mul_u32_u24 v9, 2304, v9
    v_lshl_add_u32 v9, v3, 4, v9
    s_lshl_b32 s10, s9, 1
    buffer_load_dwordx4 v[16:19], v9, s[44:47], s10 offen offset:0
    buffer_load_dwordx4 v[20:23], v9, s[44:47], s10 offen offset:64
    buffer_load_dwordx4 v[24:27], v9, s[44:47], s10 offen offset:128
    v_lshrrev_b32 v9, 3, v1
    v_and_b32 v10, 2, v9
    v_and_b32 v11, 7, v1
    v_xor_b32 v10, v10, v11
    v_mul_u32_u24 v9, 13824, v9
    v_lshl_add_u32 v11, v10, 4, v9
    v_xor_b32 v10, 4, v10
    v_lshl_add_u32 v12, v10, 4, v9
    s_mul_i32 s9, s9, 13824
    s_lshr_b32 s10, s7, 1
    s_lshl_b32 s10, s10, 7
    s_add_u32 s9, s9, s10
    s_mul_i32 s10, s6, 12288
    s_mov_b32 m0, s10
    s_nop 0
    buffer_load_dwordx4 v11, s[40:43], s9 offen lds
    s_add_u32 m0, s10, 1024
    s_add_u32 s9, s9, 110592
    buffer_load_dwordx4 v12, s[40:43], s9 offen lds
    s_add_u32 m0, s10, 2048
    s_add_u32 s9, s9, 110592
    buffer_load_dwordx4 v11, s[40:43], s9 offen lds
    s_add_u32 m0, s10, 3072
    s_add_u32 s9, s9, 110592
    buffer_load_dwordx4 v12, s[40:43], s9 offen lds
    s_add_u32 m0, s10, 4096
    s_add_u32 s9, s9, 110592
    buffer_load_dwordx4 v11, s[40:43], s9 offen lds
    s_add_u32 m0, s10, 5120
    s_add_u32 s9, s9, 110592
    buffer_load_dwordx4 v12, s[40:43], s9 offen lds
    s_add_u32 m0, s10, 6144
    s_add_u32 s9, s9, 110592
    buffer_load_dwordx4 v11, s[40:43], s9 offen lds
    s_add_u32 m0, s10, 7168
    s_add_u32 s9, s9, 110592
    buffer_load_dwordx4 v12, s[40:43], s9 offen lds
    s_add_u32 m0, s10, 8192
    s_add_u32 s9, s9, 110592
    buffer_load_dwordx4 v11, s[40:43], s9 offen lds
    s_add_u32 m0, s10, 9216
    s_add_u32 s9, s9, 110592
    buffer_load_dwordx4 v12, s[40:43], s9 offen lds
    s_add_u32 m0, s10, 10240
    s_add_u32 s9, s9, 110592
    buffer_load_dwordx4 v11, s[40:43], s9 offen lds
    s_add_u32 m0, s10, 11264
    s_add_u32 s9, s9, 110592
    buffer_load_dwordx4 v12, s[40:43], s9 offen lds
    v_lshrrev_b32 v9, 2, v2
    v_lshl_add_u32 v9, v3, 3, v9
    v_lshlrev_b32 v9, 7, v9
    v_and_b32 v10, 1, v2
    v_lshl_add_u32 v9, v10, 3, v9
    v_add_u32 v9, s10, v9
    v_and_b32 v10, 1, v3
    v_lshrrev_b32 v11, 3, v2
    v_lshl_or_b32 v10, v10, 1, v11
    v_lshlrev_b32 v10, 1, v10
    v_bfe_u32 v11, v2, 1, 1
    v_or_b32 v10, v10, v11
    v_xor_b32 v11, 0, v10
    v_lshl_add_u32 v108, v11, 4, v9
    v_xor_b32 v11, 2, v10
    v_lshl_add_u32 v109, v11, 4, v9
    v_xor_b32 v11, 4, v10
    v_lshl_add_u32 v110, v11, 4, v9
    v_xor_b32 v11, 6, v10
    v_lshl_add_u32 v111, v11, 4, v9
    s_waitcnt vmcnt(12)
    v_lshlrev_b32 v28, 16, v16
    v_and_b32 v29, 0xffff0000, v16
    v_lshlrev_b32 v30, 16, v17
    v_and_b32 v31, 0xffff0000, v17
    v_lshlrev_b32 v32, 16, v18
    v_and_b32 v33, 0xffff0000, v18
    v_lshlrev_b32 v34, 16, v19
    v_and_b32 v35, 0xffff0000, v19
    v_lshlrev_b32 v36, 16, v20
    v_and_b32 v37, 0xffff0000, v20
    v_lshlrev_b32 v38, 16, v21
    v_and_b32 v39, 0xffff0000, v21
    v_lshlrev_b32 v40, 16, v22
    v_and_b32 v41, 0xffff0000, v22
    v_lshlrev_b32 v42, 16, v23
    v_and_b32 v43, 0xffff0000, v23
    v_lshlrev_b32 v44, 16, v24
    v_and_b32 v45, 0xffff0000, v24
    v_lshlrev_b32 v46, 16, v25
    v_and_b32 v47, 0xffff0000, v25
    v_lshlrev_b32 v48, 16, v26
    v_and_b32 v49, 0xffff0000, v26
    v_lshlrev_b32 v50, 16, v27
    v_and_b32 v51, 0xffff0000, v27
    v_mul_f32 v52, 0xbfb8aa3b, v28
    v_mul_f32 v53, 0xbfb8aa3b, v29
    v_mul_f32 v54, 0xbfb8aa3b, v30
    v_mul_f32 v55, 0xbfb8aa3b, v31
    v_mul_f32 v56, 0xbfb8aa3b, v32
    v_mul_f32 v57, 0xbfb8aa3b, v33
    v_mul_f32 v58, 0xbfb8aa3b, v34
    v_mul_f32 v59, 0xbfb8aa3b, v35
    v_mul_f32 v60, 0xbfb8aa3b, v36
    v_mul_f32 v61, 0xbfb8aa3b, v37
    v_mul_f32 v62, 0xbfb8aa3b, v38
    v_mul_f32 v63, 0xbfb8aa3b, v39
    v_mul_f32 v64, 0xbfb8aa3b, v40
    v_mul_f32 v65, 0xbfb8aa3b, v41
    v_mul_f32 v66, 0xbfb8aa3b, v42
    v_mul_f32 v67, 0xbfb8aa3b, v43
    v_mul_f32 v68, 0xbfb8aa3b, v44
    v_mul_f32 v69, 0xbfb8aa3b, v45
    v_mul_f32 v70, 0xbfb8aa3b, v46
    v_mul_f32 v71, 0xbfb8aa3b, v47
    v_mul_f32 v72, 0xbfb8aa3b, v48
    v_mul_f32 v73, 0xbfb8aa3b, v49
    v_mul_f32 v74, 0xbfb8aa3b, v50
    v_mul_f32 v75, 0xbfb8aa3b, v51
    v_exp_f32 v52, v52
    v_exp_f32 v53, v53
    v_exp_f32 v54, v54
    v_exp_f32 v55, v55
    v_exp_f32 v56, v56
    v_exp_f32 v57, v57
    v_exp_f32 v58, v58
    v_exp_f32 v59, v59
    v_exp_f32 v60, v60
    v_exp_f32 v61, v61
    v_exp_f32 v62, v62
    v_exp_f32 v63, v63
    v_exp_f32 v64, v64
    v_exp_f32 v65, v65
    v_exp_f32 v66, v66
    v_exp_f32 v67, v67
    v_exp_f32 v68, v68
    v_exp_f32 v69, v69
    v_exp_f32 v70, v70
    v_exp_f32 v71, v71
    v_exp_f32 v72, v72
    v_exp_f32 v73, v73
    v_exp_f32 v74, v74
    v_exp_f32 v75, v75
    v_add_f32 v52, 1.0, v52
    v_add_f32 v53, 1.0, v53
    v_add_f32 v54, 1.0, v54
    v_add_f32 v55, 1.0, v55
    v_add_f32 v56, 1.0, v56
    v_add_f32 v57, 1.0, v57
    v_add_f32 v58, 1.0, v58
    v_add_f32 v59, 1.0, v59
    v_add_f32 v60, 1.0, v60
    v_add_f32 v61, 1.0, v61
    v_add_f32 v62, 1.0, v62
    v_add_f32 v63, 1.0, v63
    v_add_f32 v64, 1.0, v64
    v_add_f32 v65, 1.0, v65
    v_add_f32 v66, 1.0, v66
    v_add_f32 v67, 1.0, v67
    v_add_f32 v68, 1.0, v68
    v_add_f32 v69, 1.0, v69
    v_add_f32 v70, 1.0, v70
    v_add_f32 v71, 1.0, v71
    v_add_f32 v72, 1.0, v72
    v_add_f32 v73, 1.0, v73
    v_add_f32 v74, 1.0, v74
    v_add_f32 v75, 1.0, v75
    v_rcp_f32 v52, v52
    v_rcp_f32 v53, v53
    v_rcp_f32 v54, v54
    v_rcp_f32 v55, v55
    v_rcp_f32 v56, v56
    v_rcp_f32 v57, v57
    v_rcp_f32 v58, v58
    v_rcp_f32 v59, v59
    v_rcp_f32 v60, v60
    v_rcp_f32 v61, v61
    v_rcp_f32 v62, v62
    v_rcp_f32 v63, v63
    v_rcp_f32 v64, v64
    v_rcp_f32 v65, v65
    v_rcp_f32 v66, v66
    v_rcp_f32 v67, v67
    v_rcp_f32 v68, v68
    v_rcp_f32 v69, v69
    v_rcp_f32 v70, v70
    v_rcp_f32 v71, v71
    v_rcp_f32 v72, v72
    v_rcp_f32 v73, v73
    v_rcp_f32 v74, v74
    v_rcp_f32 v75, v75
    v_mul_f32 v28, v28, v52
    v_mul_f32 v29, v29, v53
    v_mul_f32 v30, v30, v54
    v_mul_f32 v31, v31, v55
    v_mul_f32 v32, v32, v56
    v_mul_f32 v33, v33, v57
    v_mul_f32 v34, v34, v58
    v_mul_f32 v35, v35, v59
    v_mul_f32 v36, v36, v60
    v_mul_f32 v37, v37, v61
    v_mul_f32 v38, v38, v62
    v_mul_f32 v39, v39, v63
    v_mul_f32 v40, v40, v64
    v_mul_f32 v41, v41, v65
    v_mul_f32 v42, v42, v66
    v_mul_f32 v43, v43, v67
    v_mul_f32 v44, v44, v68
    v_mul_f32 v45, v45, v69
    v_mul_f32 v46, v46, v70
    v_mul_f32 v47, v47, v71
    v_mul_f32 v48, v48, v72
    v_mul_f32 v49, v49, v73
    v_mul_f32 v50, v50, v74
    v_mul_f32 v51, v51, v75
    v_cvt_pk_bf16_f32 v16, v28, v29
    v_cvt_pk_bf16_f32 v17, v30, v31
    v_cvt_pk_bf16_f32 v18, v32, v33
    v_cvt_pk_bf16_f32 v19, v34, v35
    v_cvt_pk_bf16_f32 v20, v36, v37
    v_cvt_pk_bf16_f32 v21, v38, v39
    v_cvt_pk_bf16_f32 v22, v40, v41
    v_cvt_pk_bf16_f32 v23, v42, v43
    v_cvt_pk_bf16_f32 v24, v44, v45
    v_cvt_pk_bf16_f32 v25, v46, v47
    v_cvt_pk_bf16_f32 v26, v48, v49
    v_cvt_pk_bf16_f32 v27, v50, v51
    s_waitcnt vmcnt(8)
    ds_read_b64_tr_b16 v[76:77], v108 offset:0
    ds_read_b64_tr_b16 v[78:79], v108 offset:512
    ds_read_b64_tr_b16 v[80:81], v109 offset:0
    ds_read_b64_tr_b16 v[82:83], v109 offset:512
    ds_read_b64_tr_b16 v[84:85], v110 offset:0
    ds_read_b64_tr_b16 v[86:87], v110 offset:512
    ds_read_b64_tr_b16 v[88:89], v111 offset:0
    ds_read_b64_tr_b16 v[90:91], v111 offset:512
    s_waitcnt lgkmcnt(6)
    v_mfma_f32_16x16x32_bf16 v[92:95], v[16:19], v[76:79], 0
    s_waitcnt lgkmcnt(4)
    v_mfma_f32_16x16x32_bf16 v[96:99], v[16:19], v[80:83], 0
    s_waitcnt lgkmcnt(2)
    v_mfma_f32_16x16x32_bf16 v[100:103], v[16:19], v[84:87], 0
    s_waitcnt lgkmcnt(0)
    v_mfma_f32_16x16x32_bf16 v[104:107], v[16:19], v[88:91], 0
    s_waitcnt vmcnt(4)
    ds_read_b64_tr_b16 v[76:77], v108 offset:4096
    ds_read_b64_tr_b16 v[78:79], v108 offset:4608
    ds_read_b64_tr_b16 v[80:81], v109 offset:4096
    ds_read_b64_tr_b16 v[82:83], v109 offset:4608
    ds_read_b64_tr_b16 v[84:85], v110 offset:4096
    ds_read_b64_tr_b16 v[86:87], v110 offset:4608
    ds_read_b64_tr_b16 v[88:89], v111 offset:4096
    ds_read_b64_tr_b16 v[90:91], v111 offset:4608
    s_waitcnt lgkmcnt(6)
    v_mfma_f32_16x16x32_bf16 v[92:95], v[20:23], v[76:79], v[92:95]
    s_waitcnt lgkmcnt(4)
    v_mfma_f32_16x16x32_bf16 v[96:99], v[20:23], v[80:83], v[96:99]
    s_waitcnt lgkmcnt(2)
    v_mfma_f32_16x16x32_bf16 v[100:103], v[20:23], v[84:87], v[100:103]
    s_waitcnt lgkmcnt(0)
    v_mfma_f32_16x16x32_bf16 v[104:107], v[20:23], v[88:91], v[104:107]
    s_waitcnt vmcnt(0)
    ds_read_b64_tr_b16 v[76:77], v108 offset:8192
    ds_read_b64_tr_b16 v[78:79], v108 offset:8704
    ds_read_b64_tr_b16 v[80:81], v109 offset:8192
    ds_read_b64_tr_b16 v[82:83], v109 offset:8704
    ds_read_b64_tr_b16 v[84:85], v110 offset:8192
    ds_read_b64_tr_b16 v[86:87], v110 offset:8704
    ds_read_b64_tr_b16 v[88:89], v111 offset:8192
    ds_read_b64_tr_b16 v[90:91], v111 offset:8704
    s_waitcnt lgkmcnt(6)
    v_mfma_f32_16x16x32_bf16 v[92:95], v[24:27], v[76:79], v[92:95]
    s_waitcnt lgkmcnt(4)
    v_mfma_f32_16x16x32_bf16 v[96:99], v[24:27], v[80:83], v[96:99]
    s_waitcnt lgkmcnt(2)
    v_mfma_f32_16x16x32_bf16 v[100:103], v[24:27], v[84:87], v[100:103]
    s_waitcnt lgkmcnt(0)
    v_mfma_f32_16x16x32_bf16 v[104:107], v[24:27], v[88:91], v[104:107]
    s_lshl_b32 s9, s6, 9
    s_add_u32 s9, s9, 73728
    v_lshl_add_u32 v9, v2, 2, s9
    s_nop 4
    s_mov_b64 exec, 0xffff
    ds_write2st64_b32 v9, v92, v93 offset0:0 offset1:1
    v_add_u32 v9, 64, v9
    ds_write2st64_b32 v9, v96, v97 offset0:0 offset1:1
    v_add_u32 v9, 64, v9
    ds_write2st64_b32 v9, v100, v101 offset0:0 offset1:1
    v_add_u32 v9, 64, v9
    ds_write2st64_b32 v9, v104, v105 offset0:0 offset1:1
    s_mov_b64 exec, -1
    s_waitcnt lgkmcnt(0)
    s_barrier
    s_barrier
    s_mov_b32 s76, s22
    s_mov_b32 s77, s23
    s_mov_b32 s78, 7962624
    s_mov_b32 s79, 0x20000
    s_lshl_b32 s14, s12, 6
    s_add_u32 s14, s14, 14592
    v_add_u32 v6, s14, v1
    s_mov_b32 s15, 5888
    s_and_b32 s14, s4, 7
    s_mul_i32 s14, s14, 27
    s_lshr_b32 s14, s14, 2
    s_lshl_b32 s14, s14, 7
    v_cvt_f32_u32 v7, v6
    v_add_f32 v7, 0.5, v7
    v_mul_f32 v7, 0x3c800000, v7
    v_cvt_u32_f32 v7, v7
    v_mul_lo_u32 v7, v7, s15
    v_lshl_add_u32 v8, v6, 4, v7
    v_add_u32 v8, s14, v8
    s_waitcnt vmcnt(7)
    buffer_load_dwordx4 v[252:255], v8, s[76:79], 0 offen
    v_add_u32 v6, 5376, v6
    v_cvt_f32_u32 v7, v6
    v_add_f32 v7, 0.5, v7
    v_mul_f32 v7, 0x3c800000, v7
    v_cvt_u32_f32 v7, v7
    v_mul_lo_u32 v7, v7, s15
    v_lshl_add_u32 v8, v6, 4, v7
    v_add_u32 v8, s14, v8
    s_waitcnt vmcnt(7)
    buffer_load_dwordx4 v[252:255], v8, s[76:79], 0 offen
    v_add_u32 v6, 5376, v6
    v_cvt_f32_u32 v7, v6
    v_add_f32 v7, 0.5, v7
    v_mul_f32 v7, 0x3c800000, v7
    v_cvt_u32_f32 v7, v7
    v_mul_lo_u32 v7, v7, s15
    v_lshl_add_u32 v8, v6, 4, v7
    v_add_u32 v8, s14, v8
    s_waitcnt vmcnt(7)
    buffer_load_dwordx4 v[252:255], v8, s[76:79], 0 offen
    v_add_u32 v6, 5376, v6
    v_cvt_f32_u32 v7, v6
    v_add_f32 v7, 0.5, v7
    v_mul_f32 v7, 0x3c800000, v7
    v_cvt_u32_f32 v7, v7
    v_mul_lo_u32 v7, v7, s15
    v_lshl_add_u32 v8, v6, 4, v7
    v_add_u32 v8, s14, v8
    s_waitcnt vmcnt(7)
    buffer_load_dwordx4 v[252:255], v8, s[76:79], 0 offen
    v_add_u32 v6, 5376, v6
    v_cvt_f32_u32 v7, v6
    v_add_f32 v7, 0.5, v7
    v_mul_f32 v7, 0x3c800000, v7
    v_cvt_u32_f32 v7, v7
    v_mul_lo_u32 v7, v7, s15
    v_lshl_add_u32 v8, v6, 4, v7
    v_add_u32 v8, s14, v8
    s_waitcnt vmcnt(7)
    buffer_load_dwordx4 v[252:255], v8, s[76:79], 0 offen
    v_add_u32 v6, 5376, v6
    v_cvt_f32_u32 v7, v6
    v_add_f32 v7, 0.5, v7
    v_mul_f32 v7, 0x3c800000, v7
    v_cvt_u32_f32 v7, v7
    v_mul_lo_u32 v7, v7, s15
    v_lshl_add_u32 v8, v6, 4, v7
    v_add_u32 v8, s14, v8
    s_waitcnt vmcnt(7)
    buffer_load_dwordx4 v[252:255], v8, s[76:79], 0 offen
    v_add_u32 v6, 5376, v6
    v_cvt_f32_u32 v7, v6
    v_add_f32 v7, 0.5, v7
    v_mul_f32 v7, 0x3c800000, v7
    v_cvt_u32_f32 v7, v7
    v_mul_lo_u32 v7, v7, s15
    v_lshl_add_u32 v8, v6, 4, v7
    v_add_u32 v8, s14, v8
    s_waitcnt vmcnt(7)
    buffer_load_dwordx4 v[252:255], v8, s[76:79], 0 offen
    v_add_u32 v6, 5376, v6
    v_cvt_f32_u32 v7, v6
    v_add_f32 v7, 0.5, v7
    v_mul_f32 v7, 0x3c800000, v7
    v_cvt_u32_f32 v7, v7
    v_mul_lo_u32 v7, v7, s15
    v_lshl_add_u32 v8, v6, 4, v7
    v_add_u32 v8, s14, v8
    s_waitcnt vmcnt(7)
    buffer_load_dwordx4 v[252:255], v8, s[76:79], 0 offen
    v_add_u32 v6, 5376, v6
    v_cvt_f32_u32 v7, v6
    v_add_f32 v7, 0.5, v7
    v_mul_f32 v7, 0x3c800000, v7
    v_cvt_u32_f32 v7, v7
    v_mul_lo_u32 v7, v7, s15
    v_lshl_add_u32 v8, v6, 4, v7
    v_add_u32 v8, s14, v8
    s_waitcnt vmcnt(7)
    buffer_load_dwordx4 v[252:255], v8, s[76:79], 0 offen
    v_add_u32 v6, 5376, v6
    v_cvt_f32_u32 v7, v6
    v_add_f32 v7, 0.5, v7
    v_mul_f32 v7, 0x3c800000, v7
    v_cvt_u32_f32 v7, v7
    v_mul_lo_u32 v7, v7, s15
    v_lshl_add_u32 v8, v6, 4, v7
    v_add_u32 v8, s14, v8
    s_waitcnt vmcnt(7)
    buffer_load_dwordx4 v[252:255], v8, s[76:79], 0 offen
    v_add_u32 v6, 5376, v6
    v_cvt_f32_u32 v7, v6
    v_add_f32 v7, 0.5, v7
    v_mul_f32 v7, 0x3c800000, v7
    v_cvt_u32_f32 v7, v7
    v_mul_lo_u32 v7, v7, s15
    v_lshl_add_u32 v8, v6, 4, v7
    v_add_u32 v8, s14, v8
    s_waitcnt vmcnt(7)
    buffer_load_dwordx4 v[252:255], v8, s[76:79], 0 offen
    s_branch ph1_pf
Lppf_12:
    s_mov_b32 s76, s22
    s_mov_b32 s77, s23
    s_mov_b32 s78, 7962624
    s_mov_b32 s79, 0x20000
    s_lshl_b32 s14, s12, 6
    s_add_u32 s14, s14, 14592
    v_add_u32 v6, s14, v1
    s_mov_b32 s15, 5888
    s_and_b32 s14, s4, 7
    s_mul_i32 s14, s14, 27
    s_lshr_b32 s14, s14, 2
    s_lshl_b32 s14, s14, 7
    v_cvt_f32_u32 v7, v6
    v_add_f32 v7, 0.5, v7
    v_mul_f32 v7, 0x3c800000, v7
    v_cvt_u32_f32 v7, v7
    v_mul_lo_u32 v7, v7, s15
    v_lshl_add_u32 v8, v6, 4, v7
    v_add_u32 v8, s14, v8
    s_waitcnt vmcnt(7)
    buffer_load_dwordx4 v[252:255], v8, s[76:79], 0 offen
    v_add_u32 v6, 5376, v6
    v_cvt_f32_u32 v7, v6
    v_add_f32 v7, 0.5, v7
    v_mul_f32 v7, 0x3c800000, v7
    v_cvt_u32_f32 v7, v7
    v_mul_lo_u32 v7, v7, s15
    v_lshl_add_u32 v8, v6, 4, v7
    v_add_u32 v8, s14, v8
    s_waitcnt vmcnt(7)
    buffer_load_dwordx4 v[252:255], v8, s[76:79], 0 offen
    v_add_u32 v6, 5376, v6
    v_cvt_f32_u32 v7, v6
    v_add_f32 v7, 0.5, v7
    v_mul_f32 v7, 0x3c800000, v7
    v_cvt_u32_f32 v7, v7
    v_mul_lo_u32 v7, v7, s15
    v_lshl_add_u32 v8, v6, 4, v7
    v_add_u32 v8, s14, v8
    s_waitcnt vmcnt(7)
    buffer_load_dwordx4 v[252:255], v8, s[76:79], 0 offen
    v_add_u32 v6, 5376, v6
    v_cvt_f32_u32 v7, v6
    v_add_f32 v7, 0.5, v7
    v_mul_f32 v7, 0x3c800000, v7
    v_cvt_u32_f32 v7, v7
    v_mul_lo_u32 v7, v7, s15
    v_lshl_add_u32 v8, v6, 4, v7
    v_add_u32 v8, s14, v8
    s_waitcnt vmcnt(7)
    buffer_load_dwordx4 v[252:255], v8, s[76:79], 0 offen
    v_add_u32 v6, 5376, v6
    v_cvt_f32_u32 v7, v6
    v_add_f32 v7, 0.5, v7
    v_mul_f32 v7, 0x3c800000, v7
    v_cvt_u32_f32 v7, v7
    v_mul_lo_u32 v7, v7, s15
    v_lshl_add_u32 v8, v6, 4, v7
    v_add_u32 v8, s14, v8
    s_waitcnt vmcnt(7)
    buffer_load_dwordx4 v[252:255], v8, s[76:79], 0 offen
    v_add_u32 v6, 5376, v6
    v_cvt_f32_u32 v7, v6
    v_add_f32 v7, 0.5, v7
    v_mul_f32 v7, 0x3c800000, v7
    v_cvt_u32_f32 v7, v7
    v_mul_lo_u32 v7, v7, s15
    v_lshl_add_u32 v8, v6, 4, v7
    v_add_u32 v8, s14, v8
    s_waitcnt vmcnt(7)
    buffer_load_dwordx4 v[252:255], v8, s[76:79], 0 offen
    v_add_u32 v6, 5376, v6
    v_cvt_f32_u32 v7, v6
    v_add_f32 v7, 0.5, v7
    v_mul_f32 v7, 0x3c800000, v7
    v_cvt_u32_f32 v7, v7
    v_mul_lo_u32 v7, v7, s15
    v_lshl_add_u32 v8, v6, 4, v7
    v_add_u32 v8, s14, v8
    s_waitcnt vmcnt(7)
    buffer_load_dwordx4 v[252:255], v8, s[76:79], 0 offen
    v_add_u32 v6, 5376, v6
    v_cvt_f32_u32 v7, v6
    v_add_f32 v7, 0.5, v7
    v_mul_f32 v7, 0x3c800000, v7
    v_cvt_u32_f32 v7, v7
    v_mul_lo_u32 v7, v7, s15
    v_lshl_add_u32 v8, v6, 4, v7
    v_add_u32 v8, s14, v8
    s_waitcnt vmcnt(7)
    buffer_load_dwordx4 v[252:255], v8, s[76:79], 0 offen
    v_add_u32 v6, 5376, v6
    v_cvt_f32_u32 v7, v6
    v_add_f32 v7, 0.5, v7
    v_mul_f32 v7, 0x3c800000, v7
    v_cvt_u32_f32 v7, v7
    v_mul_lo_u32 v7, v7, s15
    v_lshl_add_u32 v8, v6, 4, v7
    v_add_u32 v8, s14, v8
    s_waitcnt vmcnt(7)
    buffer_load_dwordx4 v[252:255], v8, s[76:79], 0 offen
    v_add_u32 v6, 5376, v6
    v_cvt_f32_u32 v7, v6
    v_add_f32 v7, 0.5, v7
    v_mul_f32 v7, 0x3c800000, v7
    v_cvt_u32_f32 v7, v7
    v_mul_lo_u32 v7, v7, s15
    v_lshl_add_u32 v8, v6, 4, v7
    v_add_u32 v8, s14, v8
    s_waitcnt vmcnt(7)
    buffer_load_dwordx4 v[252:255], v8, s[76:79], 0 offen
    v_add_u32 v6, 5376, v6
    v_cvt_f32_u32 v7, v6
    v_add_f32 v7, 0.5, v7
    v_mul_f32 v7, 0x3c800000, v7
    v_cvt_u32_f32 v7, v7
    v_mul_lo_u32 v7, v7, s15
    v_lshl_add_u32 v8, v6, 4, v7
    v_add_u32 v8, s14, v8
    s_waitcnt vmcnt(7)
    buffer_load_dwordx4 v[252:255], v8, s[76:79], 0 offen
    s_branch ph1_pf
Lpub_11:
    s_cmp_ge_u32 s7, 108
    s_cbranch_scc1 ph1_fin
    s_cmp_eq_u32 s6, 7
    s_cbranch_scc1 ph1_bar2
    s_waitcnt lgkmcnt(0)
    s_add_u32 s3, s3, 0x9e3779b1
    s_mov_b32 s10, s3
    s_add_u32 s48, s38, 8912896
    s_addc_u32 s49, s39, 0
    s_mov_b32 s50, 444416
    s_mov_b32 s51, 0x20000
    v_add_u32 v6, 73728, v5
    v_lshrrev_b32 v7, 4, v1
    v_mul_u32_u24 v7, 13824, v7
    v_lshl_add_u32 v7, v2, 4, v7
    s_and_b32 s9, s7, 1
    s_mul_i32 s9, s9, 27648
    s_lshr_b32 s11, s7, 1
    s_lshl_b32 s11, s11, 8
    s_add_u32 s9, s9, s11
    s_and_b32 s68, s10, 0xff
    s_bfe_u32 s69, s10, 0x80008
    s_bfe_u32 s70, s10, 0x80010
    s_lshr_b32 s71, s10, 24
    s_mov_b32 exec_hi, 0
    s_barrier
    ds_read_b128 v[8:11], v6 offset:0
    ds_read_b128 v[12:15], v6 offset:512
    ds_read_b128 v[16:19], v6 offset:1024
    ds_read_b128 v[20:23], v6 offset:1536
    ds_read_b128 v[24:27], v6 offset:2048
    ds_read_b128 v[28:31], v6 offset:2560
    s_waitcnt lgkmcnt(4)
    v_pk_add_f32 v[8:9], v[8:9], v[12:13]
    v_pk_add_f32 v[10:11], v[10:11], v[14:15]
    s_waitcnt lgkmcnt(3)
    v_pk_add_f32 v[8:9], v[8:9], v[16:17]
    v_pk_add_f32 v[10:11], v[10:11], v[18:19]
    s_waitcnt lgkmcnt(2)
    v_pk_add_f32 v[8:9], v[8:9], v[20:21]
    v_pk_add_f32 v[10:11], v[10:11], v[22:23]
    s_waitcnt lgkmcnt(1)
    v_pk_add_f32 v[8:9], v[8:9], v[24:25]
    v_pk_add_f32 v[10:11], v[10:11], v[26:27]
    s_waitcnt lgkmcnt(0)
    v_pk_add_f32 v[8:9], v[8:9], v[28:29]
    v_pk_add_f32 v[10:11], v[10:11], v[30:31]
    v_and_b32 v8, 0xffffff00, v8
    v_and_b32 v9, 0xffffff00, v9
    v_and_b32 v10, 0xffffff00, v10
    v_and_b32 v11, 0xffffff00, v11
    v_or_b32 v8, s68, v8
    v_or_b32 v9, s69, v9
    v_or_b32 v10, s70, v10
    v_or_b32 v11, s71, v11
    buffer_store_dwordx4 v[8:11], v7, s[48:51], s9 offen sc1
    s_add_u32 s9, s9, 55552
Lpub_11x:
    s_mov_b64 exec, -1
    s_waitcnt vmcnt(0)
    s_barrier
    s_branch ph1__fin
ph1_bar2:
    s_barrier
    s_branch ph1_bar
k1_spare:
    s_lshl_b32 s12, s5, 3
    s_add_u32 s12, s12, s6
    s_mul_i32 s13, s4, 48
    s_add_u32 s13, s13, s12
    s_mov_b32 s76, s20
    s_mov_b32 s77, s21
    s_mov_b32 s78, 354816
    s_mov_b32 s79, 0x20000
    s_lshl_b32 s14, s12, 10
    s_add_u32 s14, s14, 0
    v_add_u32 v8, s14, v5
    s_waitcnt vmcnt(2)
    buffer_load_dwordx4 v[252:255], v8, s[76:79], 0 offen
    v_add_u32 v8, 49152, v8
    s_waitcnt vmcnt(2)
    buffer_load_dwordx4 v[252:255], v8, s[76:79], 0 offen
    v_add_u32 v8, 49152, v8
    s_waitcnt vmcnt(2)
    buffer_load_dwordx4 v[252:255], v8, s[76:79], 0 offen
    v_add_u32 v8, 49152, v8
    s_waitcnt vmcnt(2)
    buffer_load_dwordx4 v[252:255], v8, s[76:79], 0 offen
    v_add_u32 v8, 49152, v8
    s_waitcnt vmcnt(2)
    buffer_load_dwordx4 v[252:255], v8, s[76:79], 0 offen
    v_add_u32 v8, 49152, v8
    s_waitcnt vmcnt(2)
    buffer_load_dwordx4 v[252:255], v8, s[76:79], 0 offen
    v_add_u32 v8, 49152, v8
    s_waitcnt vmcnt(2)
    buffer_load_dwordx4 v[252:255], v8, s[76:79], 0 offen
    v_add_u32 v8, 49152, v8
    s_waitcnt vmcnt(2)
    buffer_load_dwordx4 v[252:255], v8, s[76:79], 0 offen
    s_mov_b32 s76, s28
    s_mov_b32 s77, s29
    s_mov_b32 s78, 5308416
    s_mov_b32 s79, 0x20000
    s_lshl_b32 s14, s12, 6
    s_add_u32 s14, s14, 0
    v_add_u32 v6, s14, v1
    s_mov_b32 s15, 4352
    s_and_b32 s14, s4, 7
    s_mul_i32 s14, s14, 2
    s_lshr_b32 s14, s14, 0
    s_lshl_b32 s14, s14, 7
    v_cvt_f32_u32 v7, v6
    v_add_f32 v7, 0.5, v7
    v_mul_f32 v7, 0x3d800000, v7
    v_cvt_u32_f32 v7, v7
    v_mul_lo_u32 v7, v7, s15
    v_lshl_add_u32 v8, v6, 4, v7
    v_add_u32 v8, s14, v8
    s_waitcnt vmcnt(2)
    buffer_load_dwordx4 v[252:255], v8, s[76:79], 0 offen
    v_add_u32 v6, 3072, v6
    v_cvt_f32_u32 v7, v6
    v_add_f32 v7, 0.5, v7
    v_mul_f32 v7, 0x3d800000, v7
    v_cvt_u32_f32 v7, v7
    v_mul_lo_u32 v7, v7, s15
    v_lshl_add_u32 v8, v6, 4, v7
    v_add_u32 v8, s14, v8
    s_waitcnt vmcnt(2)
    buffer_load_dwordx4 v[252:255], v8, s[76:79], 0 offen
    v_add_u32 v6, 3072, v6
    v_cvt_f32_u32 v7, v6
    v_add_f32 v7, 0.5, v7
    v_mul_f32 v7, 0x3d800000, v7
    v_cvt_u32_f32 v7, v7
    v_mul_lo_u32 v7, v7, s15
    v_lshl_add_u32 v8, v6, 4, v7
    v_add_u32 v8, s14, v8
    s_waitcnt vmcnt(2)
    buffer_load_dwordx4 v[252:255], v8, s[76:79], 0 offen
    v_add_u32 v6, 3072, v6
    v_cvt_f32_u32 v7, v6
    v_add_f32 v7, 0.5, v7
    v_mul_f32 v7, 0x3d800000, v7
    v_cvt_u32_f32 v7, v7
    v_mul_lo_u32 v7, v7, s15
    v_lshl_add_u32 v8, v6, 4, v7
    v_add_u32 v8, s14, v8
    s_waitcnt vmcnt(2)
    buffer_load_dwordx4 v[252:255], v8, s[76:79], 0 offen
    v_add_u32 v6, 3072, v6
    v_cvt_f32_u32 v7, v6
    v_add_f32 v7, 0.5, v7
    v_mul_f32 v7, 0x3d800000, v7
    v_cvt_u32_f32 v7, v7
    v_mul_lo_u32 v7, v7, s15
    v_lshl_add_u32 v8, v6, 4, v7
    v_add_u32 v8, s14, v8
    s_waitcnt vmcnt(2)
    buffer_load_dwordx4 v[252:255], v8, s[76:79], 0 offen
    v_add_u32 v6, 3072, v6
    v_cvt_f32_u32 v7, v6
    v_add_f32 v7, 0.5, v7
    v_mul_f32 v7, 0x3d800000, v7
    v_cvt_u32_f32 v7, v7
    v_mul_lo_u32 v7, v7, s15
    v_lshl_add_u32 v8, v6, 4, v7
    v_add_u32 v8, s14, v8
    s_waitcnt vmcnt(2)
    buffer_load_dwordx4 v[252:255], v8, s[76:79], 0 offen
    s_cmp_ge_u32 s5, 5
    s_cbranch_scc1 ph1_pf
    s_mul_i32 s13, s4, 40
    s_add_u32 s13, s13, s12
    s_mov_b32 s76, s26
    s_mov_b32 s77, s27
    s_mov_b32 s78, 2654208
    s_mov_b32 s79, 0x20000
    s_lshl_b32 s14, s13, 10
    s_add_u32 s14, s14, 0
    v_add_u32 v8, s14, v5
    s_waitcnt vmcnt(2)
    buffer_load_dwordx4 v[252:255], v8, s[76:79], 0 offen
    v_add_u32 v8, 327680, v8
    s_waitcnt vmcnt(2)
    buffer_load_dwordx4 v[252:255], v8, s[76:79], 0 offen
    v_add_u32 v8, 327680, v8
    s_waitcnt vmcnt(2)
    buffer_load_dwordx4 v[252:255], v8, s[76:79], 0 offen
    v_add_u32 v8, 327680, v8
    s_waitcnt vmcnt(2)
    buffer_load_dwordx4 v[252:255], v8, s[76:79], 0 offen
    v_add_u32 v8, 327680, v8
    s_waitcnt vmcnt(2)
    buffer_load_dwordx4 v[252:255], v8, s[76:79], 0 offen
    v_add_u32 v8, 327680, v8
    s_waitcnt vmcnt(2)
    buffer_load_dwordx4 v[252:255], v8, s[76:79], 0 offen
    v_add_u32 v8, 327680, v8
    s_waitcnt vmcnt(2)
    buffer_load_dwordx4 v[252:255], v8, s[76:79], 0 offen
    v_add_u32 v8, 327680, v8
    s_waitcnt vmcnt(2)
    buffer_load_dwordx4 v[252:255], v8, s[76:79], 0 offen
    v_add_u32 v8, 327680, v8
    s_waitcnt vmcnt(2)
    buffer_load_dwordx4 v[252:255], v8, s[76:79], 0 offen
ph1_pf:
    s_waitcnt lgkmcnt(0)
    s_add_u32 s3, s3, 0x9e3779b1
    s_branch ph1__now
k1_rows:
    s_lshl_b32 s7, s4, 2
    s_add_u32 s7, s7, s5
    s_sub_u32 s7, s7, 28
    s_lshr_b32 s8, s7, 3
    s_lshl_b32 s8, s8, 7
    s_and_b32 s9, s7, 7
    s_lshl_b32 s9, s9, 2
    s_add_u32 s93, s8, s9
    s_movk_i32 s100, 64
    s_cmp_ge_u32 s6, 6
    s_cbranch_scc1 ph1_bar
    s_mov_b32 s40, s16
    s_mov_b32 s41, s17
    s_mov_b32 s42, 1179648
    s_mov_b32 s43, 0x20000
    s_add_u32 s44, s38, 8912896
    s_addc_u32 s45, s39, 0
    s_mov_b32 s46, 444416
    s_mov_b32 s47, 0x20000
    s_add_u32 s48, s38, 0
    s_addc_u32 s49, s39, 0
    s_mov_b32 s50, 1179648
    s_mov_b32 s51, 0x20000
    s_lshl_b32 s8, s7, 4
    v_add_u32 v6, s8, v2
    v_mul_u32_u24 v6, 2304, v6
    v_lshl_add_u32 v6, v3, 4, v6
    s_mul_i32 s8, s6, 384
    buffer_load_dwordx4 v[12:15], v6, s[40:43], s8 offen offset:0
    buffer_load_dwordx4 v[16:19], v6, s[40:43], s8 offen offset:64
    buffer_load_dwordx4 v[20:23], v6, s[40:43], s8 offen offset:128
    buffer_load_dwordx4 v[24:27], v6, s[40:43], s8 offen offset:192
    buffer_load_dwordx4 v[28:31], v6, s[40:43], s8 offen offset:256
    buffer_load_dwordx4 v[32:35], v6, s[40:43], s8 offen offset:320
    s_waitcnt lgkmcnt(0)
    s_add_u32 s3, s3, 0x9e3779b1
    s_mov_b32 s10, s3
    s_waitcnt vmcnt(0)
    v_lshlrev_b32 v36, 16, v12
    v_and_b32 v37, 0xffff0000, v12
    v_lshlrev_b32 v38, 16, v13
    v_and_b32 v39, 0xffff0000, v13
    v_lshlrev_b32 v40, 16, v14
    v_and_b32 v41, 0xffff0000, v14
    v_lshlrev_b32 v42, 16, v15
    v_and_b32 v43, 0xffff0000, v15
    v_lshlrev_b32 v44, 16, v16
    v_and_b32 v45, 0xffff0000, v16
    v_lshlrev_b32 v46, 16, v17
    v_and_b32 v47, 0xffff0000, v17
    v_lshlrev_b32 v48, 16, v18
    v_and_b32 v49, 0xffff0000, v18
    v_lshlrev_b32 v50, 16, v19
    v_and_b32 v51, 0xffff0000, v19
    v_lshlrev_b32 v52, 16, v20
    v_and_b32 v53, 0xffff0000, v20
    v_lshlrev_b32 v54, 16, v21
    v_and_b32 v55, 0xffff0000, v21
    v_lshlrev_b32 v56, 16, v22
    v_and_b32 v57, 0xffff0000, v22
    v_lshlrev_b32 v58, 16, v23
    v_and_b32 v59, 0xffff0000, v23
    v_lshlrev_b32 v60, 16, v24
    v_and_b32 v61, 0xffff0000, v24
    v_lshlrev_b32 v62, 16, v25
    v_and_b32 v63, 0xffff0000, v25
    v_lshlrev_b32 v64, 16, v26
    v_and_b32 v65, 0xffff0000, v26
    v_lshlrev_b32 v66, 16, v27
    v_and_b32 v67, 0xffff0000, v27
    v_lshlrev_b32 v68, 16, v28
    v_and_b32 v69, 0xffff0000, v28
    v_lshlrev_b32 v70, 16, v29
    v_and_b32 v71, 0xffff0000, v29
    v_lshlrev_b32 v72, 16, v30
    v_and_b32 v73, 0xffff0000, v30
    v_lshlrev_b32 v74, 16, v31
    v_and_b32 v75, 0xffff0000, v31
    v_lshlrev_b32 v76, 16, v32
    v_and_b32 v77, 0xffff0000, v32
    v_lshlrev_b32 v78, 16, v33
    v_and_b32 v79, 0xffff0000, v33
    v_lshlrev_b32 v80, 16, v34
    v_and_b32 v81, 0xffff0000, v34
    v_lshlrev_b32 v82, 16, v35
    v_and_b32 v83, 0xffff0000, v35
    v_pk_add_f32 v[84:85], v[36:37], v[38:39]
    v_pk_add_f32 v[84:85], v[84:85], v[40:41]
    v_pk_add_f32 v[84:85], v[84:85], v[42:43]
    v_pk_add_f32 v[84:85], v[84:85], v[44:45]
    v_pk_add_f32 v[84:85], v[84:85], v[46:47]
    v_pk_add_f32 v[84:85], v[84:85], v[48:49]
    v_pk_add_f32 v[84:85], v[84:85], v[50:51]
    v_pk_add_f32 v[84:85], v[84:85], v[52:53]
    v_pk_add_f32 v[84:85], v[84:85], v[54:55]
    v_pk_add_f32 v[84:85], v[84:85], v[56:57]
    v_pk_add_f32 v[84:85], v[84:85], v[58:59]
    v_pk_add_f32 v[84:85], v[84:85], v[60:61]
    v_pk_add_f32 v[84:85], v[84:85], v[62:63]
    v_pk_add_f32 v[84:85], v[84:85], v[64:65]
    v_pk_add_f32 v[84:85], v[84:85], v[66:67]
    v_pk_add_f32 v[84:85], v[84:85], v[68:69]
    v_pk_add_f32 v[84:85], v[84:85], v[70:71]
    v_pk_add_f32 v[84:85], v[84:85], v[72:73]
    v_pk_add_f32 v[84:85], v[84:85], v[74:75]
    v_pk_add_f32 v[84:85], v[84:85], v[76:77]
    v_pk_add_f32 v[84:85], v[84:85], v[78:79]
    v_pk_add_f32 v[84:85], v[84:85], v[80:81]
    v_pk_add_f32 v[84:85], v[84:85], v[82:83]
    v_add_f32 v84, v84, v85
    v_mov_b32 v6, v84
    s_nop 1
    v_permlane16_swap_b32 v84, v6
    s_nop 0
    v_add_f32 v84, v84, v6
    v_mov_b32 v6, v84
    s_nop 1
    v_permlane32_swap_b32 v84, v6
    s_nop 0
    v_add_f32 v84, v84, v6
    v_mul_f32 v86, 0xbbaaaaab, v84
    v_mov_b32 v84, 0
    v_mov_b32 v85, 0
    v_mov_b32 v87, v86
    v_pk_add_f32 v[36:37], v[36:37], v[86:87]
    v_pk_add_f32 v[38:39], v[38:39], v[86:87]
    v_pk_add_f32 v[40:41], v[40:41], v[86:87]
    v_pk_add_f32 v[42:43], v[42:43], v[86:87]
    v_pk_add_f32 v[44:45], v[44:45], v[86:87]
    v_pk_add_f32 v[46:47], v[46:47], v[86:87]
    v_pk_add_f32 v[48:49], v[48:49], v[86:87]
    v_pk_add_f32 v[50:51], v[50:51], v[86:87]
    v_pk_add_f32 v[52:53], v[52:53], v[86:87]
    v_pk_add_f32 v[54:55], v[54:55], v[86:87]
    v_pk_add_f32 v[56:57], v[56:57], v[86:87]
    v_pk_add_f32 v[58:59], v[58:59], v[86:87]
    v_pk_add_f32 v[60:61], v[60:61], v[86:87]
    v_pk_add_f32 v[62:63], v[62:63], v[86:87]
    v_pk_add_f32 v[64:65], v[64:65], v[86:87]
    v_pk_add_f32 v[66:67], v[66:67], v[86:87]
    v_pk_add_f32 v[68:69], v[68:69], v[86:87]
    v_pk_add_f32 v[70:71], v[70:71], v[86:87]
    v_pk_add_f32 v[72:73], v[72:73], v[86:87]
    v_pk_add_f32 v[74:75], v[74:75], v[86:87]
    v_pk_add_f32 v[76:77], v[76:77], v[86:87]
    v_pk_add_f32 v[78:79], v[78:79], v[86:87]
    v_pk_add_f32 v[80:81], v[80:81], v[86:87]
    v_pk_add_f32 v[82:83], v[82:83], v[86:87]
    v_pk_fma_f32 v[84:85], v[36:37], v[36:37], v[84:85]
    v_pk_fma_f32 v[84:85], v[38:39], v[38:39], v[84:85]
    v_pk_fma_f32 v[84:85], v[40:41], v[40:41], v[84:85]
    v_pk_fma_f32 v[84:85], v[42:43], v[42:43], v[84:85]
    v_pk_fma_f32 v[84:85], v[44:45], v[44:45], v[84:85]
    v_pk_fma_f32 v[84:85], v[46:47], v[46:47], v[84:85]
    v_pk_fma_f32 v[84:85], v[48:49], v[48:49], v[84:85]
    v_pk_fma_f32 v[84:85], v[50:51], v[50:51], v[84:85]
    v_pk_fma_f32 v[84:85], v[52:53], v[52:53], v[84:85]
    v_pk_fma_f32 v[84:85], v[54:55], v[54:55], v[84:85]
    v_pk_fma_f32 v[84:85], v[56:57], v[56:57], v[84:85]
    v_pk_fma_f32 v[84:85], v[58:59], v[58:59], v[84:85]
    v_pk_fma_f32 v[84:85], v[60:61], v[60:61], v[84:85]
    v_pk_fma_f32 v[84:85], v[62:63], v[62:63], v[84:85]
    v_pk_fma_f32 v[84:85], v[64:65], v[64:65], v[84:85]
    v_pk_fma_f32 v[84:85], v[66:67], v[66:67], v[84:85]
    v_pk_fma_f32 v[84:85], v[68:69], v[68:69], v[84:85]
    v_pk_fma_f32 v[84:85], v[70:71], v[70:71], v[84:85]
    v_pk_fma_f32 v[84:85], v[72:73], v[72:73], v[84:85]
    v_pk_fma_f32 v[84:85], v[74:75], v[74:75], v[84:85]
    v_pk_fma_f32 v[84:85], v[76:77], v[76:77], v[84:85]
    v_pk_fma_f32 v[84:85], v[78:79], v[78:79], v[84:85]
    v_pk_fma_f32 v[84:85], v[80:81], v[80:81], v[84:85]
    v_pk_fma_f32 v[84:85], v[82:83], v[82:83], v[84:85]
    v_add_f32 v84, v84, v85
    v_mov_b32 v6, v84
    s_nop 1
    v_permlane16_swap_b32 v84, v6
    s_nop 0
    v_add_f32 v84, v84, v6
    v_mov_b32 v6, v84
    s_nop 1
    v_permlane32_swap_b32 v84, v6
    s_nop 0
    v_add_f32 v84, v84, v6
    v_mov_b32 v87, v84
    v_lshlrev_b32 v6, 3, v2
    s_lshl_b32 s8, s6, 7
    v_add_u32 v7, s8, v6
    ds_write_b64 v7, v[86:87]
    s_waitcnt lgkmcnt(0)
    s_barrier
    ds_read_b64 v[104:105], v6 offset:0
    ds_read_b64 v[106:107], v6 offset:128
    ds_read_b64 v[108:109], v6 offset:256
    ds_read_b64 v[110:111], v6 offset:384
    ds_read_b64 v[112:113], v6 offset:512
    ds_read_b64 v[114:115], v6 offset:640
    s_waitcnt lgkmcnt(0)
    v_add_f32 v6, v104, v106
    v_add_f32 v7, v105, v107
    v_add_f32 v6, v6, v108
    v_add_f32 v7, v7, v109
    v_add_f32 v6, v6, v110
    v_add_f32 v7, v7, v111
    v_add_f32 v6, v6, v112
    v_add_f32 v7, v7, v113
    v_add_f32 v6, v6, v114
    v_add_f32 v7, v7, v115
    v_mul_f32 v6, 0x3e2aaaab, v6
    v_mov_b32 v8, 0
    v_sub_f32 v104, v104, v6
    v_fmac_f32 v8, v104, v104
    v_sub_f32 v106, v106, v6
    v_fmac_f32 v8, v106, v106
    v_sub_f32 v108, v108, v6
    v_fmac_f32 v8, v108, v108
    v_sub_f32 v110, v110, v6
    v_fmac_f32 v8, v110, v110
    v_sub_f32 v112, v112, v6
    v_fmac_f32 v8, v112, v112
    v_sub_f32 v114, v114, v6
    v_fmac_f32 v8, v114, v114
    v_fmac_f32 v7, 0x43400000, v8
    v_mov_b32 v8, 0x3727c5ac
    v_fmac_f32 v8, 0x3a638e39, v7
    v_rsq_f32 v84, v8
    v_sub_f32 v86, v6, v86
    v_mov_b32 v85, v84
    v_mov_b32 v87, v86
    v_pk_add_f32 v[36:37], v[36:37], v[86:87]
    v_pk_add_f32 v[38:39], v[38:39], v[86:87]
    v_pk_add_f32 v[40:41], v[40:41], v[86:87]
    v_pk_add_f32 v[42:43], v[42:43], v[86:87]
    v_pk_add_f32 v[44:45], v[44:45], v[86:87]
    v_pk_add_f32 v[46:47], v[46:47], v[86:87]
    v_pk_add_f32 v[48:49], v[48:49], v[86:87]
    v_pk_add_f32 v[50:51], v[50:51], v[86:87]
    v_pk_add_f32 v[52:53], v[52:53], v[86:87]
    v_pk_add_f32 v[54:55], v[54:55], v[86:87]
    v_pk_add_f32 v[56:57], v[56:57], v[86:87]
    v_pk_add_f32 v[58:59], v[58:59], v[86:87]
    v_pk_add_f32 v[60:61], v[60:61], v[86:87]
    v_pk_add_f32 v[62:63], v[62:63], v[86:87]
    v_pk_add_f32 v[64:65], v[64:65], v[86:87]
    v_pk_add_f32 v[66:67], v[66:67], v[86:87]
    v_pk_add_f32 v[68:69], v[68:69], v[86:87]
    v_pk_add_f32 v[70:71], v[70:71], v[86:87]
    v_pk_add_f32 v[72:73], v[72:73], v[86:87]
    v_pk_add_f32 v[74:75], v[74:75], v[86:87]
    v_pk_add_f32 v[76:77], v[76:77], v[86:87]
    v_pk_add_f32 v[78:79], v[78:79], v[86:87]
    v_pk_add_f32 v[80:81], v[80:81], v[86:87]
    v_pk_add_f32 v[82:83], v[82:83], v[86:87]
    v_pk_mul_f32 v[36:37], v[36:37], v[84:85]
    v_pk_mul_f32 v[38:39], v[38:39], v[84:85]
    v_pk_mul_f32 v[40:41], v[40:41], v[84:85]
    v_pk_mul_f32 v[42:43], v[42:43], v[84:85]
    v_pk_mul_f32 v[44:45], v[44:45], v[84:85]
    v_pk_mul_f32 v[46:47], v[46:47], v[84:85]
    v_pk_mul_f32 v[48:49], v[48:49], v[84:85]
    v_pk_mul_f32 v[50:51], v[50:51], v[84:85]
    v_pk_mul_f32 v[52:53], v[52:53], v[84:85]
    v_pk_mul_f32 v[54:55], v[54:55], v[84:85]
    v_pk_mul_f32 v[56:57], v[56:57], v[84:85]
    v_pk_mul_f32 v[58:59], v[58:59], v[84:85]
    v_pk_mul_f32 v[60:61], v[60:61], v[84:85]
    v_pk_mul_f32 v[62:63], v[62:63], v[84:85]
    v_pk_mul_f32 v[64:65], v[64:65], v[84:85]
    v_pk_mul_f32 v[66:67], v[66:67], v[84:85]
    v_pk_mul_f32 v[68:69], v[68:69], v[84:85]
    v_pk_mul_f32 v[70:71], v[70:71], v[84:85]
    v_pk_mul_f32 v[72:73], v[72:73], v[84:85]
    v_pk_mul_f32 v[74:75], v[74:75], v[84:85]
    v_pk_mul_f32 v[76:77], v[76:77], v[84:85]
    v_pk_mul_f32 v[78:79], v[78:79], v[84:85]
    v_pk_mul_f32 v[80:81], v[80:81], v[84:85]
    v_pk_mul_f32 v[82:83], v[82:83], v[84:85]
    s_lshr_b32 s8, s7, 4
    s_mul_i32 s8, s8, 13824
    s_and_b32 s11, s7, 0
    s_mul_i32 s11, s11, 55552
    s_add_u32 s8, s8, s11
    s_mul_i32 s11, s6, 768
    s_add_u32 s12, s8, s11
    s_add_u32 s13, s12, 4608
    s_add_u32 s14, s12, 27648
    s_add_u32 s15, s14, 4608
    s_mov_b32 s68, 0x0c0c0400
    s_mov_b32 s69, 0x04000c0c
    s_mov_b32 s9, 0
    s_mov_b32 exec_hi, 0xffff
Lrp_13:
    buffer_load_dwordx4 v[88:91], v5, s[44:47], s12 offen sc1
    buffer_load_dwordx4 v[92:95], v5, s[44:47], s13 offen sc1
    buffer_load_dwordx4 v[96:99], v5, s[44:47], s14 offen sc1
    buffer_load_dwordx4 v[100:103], v5, s[44:47], s15 offen sc1
    s_waitcnt vmcnt(3)
    v_perm_b32 v6, v89, v88, s68
    v_perm_b32 v7, v91, v90, s69
    v_or_b32 v6, v6, v7
    v_xor_b32 v8, s10, v6
    s_waitcnt vmcnt(2)
    v_perm_b32 v6, v93, v92, s68
    v_perm_b32 v7, v95, v94, s69
    v_or_b32 v6, v6, v7
    v_xor_b32 v6, s10, v6
    v_or_b32 v8, v8, v6
    s_waitcnt vmcnt(1)
    v_perm_b32 v6, v97, v96, s68
    v_perm_b32 v7, v99, v98, s69
    v_or_b32 v6, v6, v7
    v_xor_b32 v6, s10, v6
    v_or_b32 v8, v8, v6
    s_waitcnt vmcnt(0)
    v_perm_b32 v6, v101, v100, s68
    v_perm_b32 v7, v103, v102, s69
    v_or_b32 v6, v6, v7
    v_xor_b32 v6, s10, v6
    v_or_b32 v8, v8, v6
    v_cmp_ne_u32 vcc, 0, v8
    s_add_u32 s9, s9, 1
    s_cmp_ge_u32 s9, 32768
    s_cbranch_scc1 Lrp_13x
    s_cbranch_vccnz Lrp_13
Lrp_13x:
    v_and_b32 v88, 0xffffff00, v88
    v_and_b32 v89, 0xffffff00, v89
    v_and_b32 v90, 0xffffff00, v90
    v_and_b32 v91, 0xffffff00, v91
    v_and_b32 v92, 0xffffff00, v92
    v_and_b32 v93, 0xffffff00, v93
    v_and_b32 v94, 0xffffff00, v94
    v_and_b32 v95, 0xffffff00, v95
    v_and_b32 v96, 0xffffff00, v96
    v_and_b32 v97, 0xffffff00, v97
    v_and_b32 v98, 0xffffff00, v98
    v_and_b32 v99, 0xffffff00, v99
    v_and_b32 v100, 0xffffff00, v100
    v_and_b32 v101, 0xffffff00, v101
    v_and_b32 v102, 0xffffff00, v102
    v_and_b32 v103, 0xffffff00, v103
    v_pk_add_f32 v[88:89], v[88:89], v[96:97]
    v_pk_add_f32 v[92:93], v[92:93], v[100:101]
    v_pk_add_f32 v[90:91], v[90:91], v[98:99]
    v_pk_add_f32 v[94:95], v[94:95], v[102:103]
    v_add_f32 v92, 1.0, v92
    v_add_f32 v93, 1.0, v93
    v_add_f32 v94, 1.0, v94
    v_add_f32 v95, 1.0, v95
    s_mul_i32 s8, s6, 1536
    s_add_u32 s8, s8, 1024
    v_add_u32 v6, s8, v5
    ds_write_b128 v6, v[88:91]
    ds_write_b128 v6, v[92:95] offset:768
    s_mov_b64 exec, -1
    v_lshl_add_u32 v6, v3, 5, s8
    s_mul_i32 s8, s6, 196608
    s_lshl_b32 s11, s7, 10
    s_add_u32 s8, s8, s11
    s_waitcnt lgkmcnt(0)
    ds_read_b128 v[104:107], v6 offset:768
    ds_read_b128 v[108:111], v6 offset:784
    ds_read_b128 v[112:115], v6 offset:0
    ds_read_b128 v[116:119], v6 offset:16
    ds_read_b128 v[120:123], v6 offset:896
    ds_read_b128 v[124:127], v6 offset:912
    ds_read_b128 v[128:131], v6 offset:128
    ds_read_b128 v[132:135], v6 offset:144
    ds_read_b128 v[136:139], v6 offset:1024
    ds_read_b128 v[140:143], v6 offset:1040
    ds_read_b128 v[144:147], v6 offset:256
    ds_read_b128 v[148:151], v6 offset:272
    s_waitcnt lgkmcnt(8)
    v_pk_fma_f32 v[36:37], v[36:37], v[104:105], v[112:113]
    v_pk_fma_f32 v[38:39], v[38:39], v[106:107], v[114:115]
    v_pk_fma_f32 v[40:41], v[40:41], v[108:109], v[116:117]
    v_pk_fma_f32 v[42:43], v[42:43], v[110:111], v[118:119]
    ds_read_b128 v[104:107], v6 offset:1152
    ds_read_b128 v[108:111], v6 offset:1168
    ds_read_b128 v[112:115], v6 offset:384
    ds_read_b128 v[116:119], v6 offset:400
    v_cvt_pk_bf16_f32 v12, v36, v37
    v_cvt_pk_bf16_f32 v13, v38, v39
    v_cvt_pk_bf16_f32 v14, v40, v41
    v_cvt_pk_bf16_f32 v15, v42, v43
    buffer_store_dwordx4 v[12:15], v5, s[48:51], s8 offen sc1
    s_add_u32 s8, s8, 32768
    s_waitcnt lgkmcnt(8)
    v_pk_fma_f32 v[44:45], v[44:45], v[120:121], v[128:129]
    v_pk_fma_f32 v[46:47], v[46:47], v[122:123], v[130:131]
    v_pk_fma_f32 v[48:49], v[48:49], v[124:125], v[132:133]
    v_pk_fma_f32 v[50:51], v[50:51], v[126:127], v[134:135]
    ds_read_b128 v[120:123], v6 offset:1280
    ds_read_b128 v[124:127], v6 offset:1296
    ds_read_b128 v[128:131], v6 offset:512
    ds_read_b128 v[132:135], v6 offset:528
    v_cvt_pk_bf16_f32 v16, v44, v45
    v_cvt_pk_bf16_f32 v17, v46, v47
    v_cvt_pk_bf16_f32 v18, v48, v49
    v_cvt_pk_bf16_f32 v19, v50, v51
    buffer_store_dwordx4 v[16:19], v5, s[48:51], s8 offen sc1
    s_add_u32 s8, s8, 32768
    s_waitcnt lgkmcnt(8)
    v_pk_fma_f32 v[52:53], v[52:53], v[136:137], v[144:145]
    v_pk_fma_f32 v[54:55], v[54:55], v[138:139], v[146:147]
    v_pk_fma_f32 v[56:57], v[56:57], v[140:141], v[148:149]
    v_pk_fma_f32 v[58:59], v[58:59], v[142:143], v[150:151]
    ds_read_b128 v[136:139], v6 offset:1408
    ds_read_b128 v[140:143], v6 offset:1424
    ds_read_b128 v[144:147], v6 offset:640
    ds_read_b128 v[148:151], v6 offset:656
    v_cvt_pk_bf16_f32 v20, v52, v53
    v_cvt_pk_bf16_f32 v21, v54, v55
    v_cvt_pk_bf16_f32 v22, v56, v57
    v_cvt_pk_bf16_f32 v23, v58, v59
    buffer_store_dwordx4 v[20:23], v5, s[48:51], s8 offen sc1
    s_add_u32 s8, s8, 32768
    s_waitcnt lgkmcnt(8)
    v_pk_fma_f32 v[60:61], v[60:61], v[104:105], v[112:113]
    v_pk_fma_f32 v[62:63], v[62:63], v[106:107], v[114:115]
    v_pk_fma_f32 v[64:65], v[64:65], v[108:109], v[116:117]
    v_pk_fma_f32 v[66:67], v[66:67], v[110:111], v[118:119]
    v_cvt_pk_bf16_f32 v24, v60, v61
    v_cvt_pk_bf16_f32 v25, v62, v63
    v_cvt_pk_bf16_f32 v26, v64, v65
    v_cvt_pk_bf16_f32 v27, v66, v67
    buffer_store_dwordx4 v[24:27], v5, s[48:51], s8 offen sc1
    s_add_u32 s8, s8, 32768
    s_waitcnt lgkmcnt(4)
    v_pk_fma_f32 v[68:69], v[68:69], v[120:121], v[128:129]
    v_pk_fma_f32 v[70:71], v[70:71], v[122:123], v[130:131]
    v_pk_fma_f32 v[72:73], v[72:73], v[124:125], v[132:133]
    v_pk_fma_f32 v[74:75], v[74:75], v[126:127], v[134:135]
    v_cvt_pk_bf16_f32 v28, v68, v69
    v_cvt_pk_bf16_f32 v29, v70, v71
    v_cvt_pk_bf16_f32 v30, v72, v73
    v_cvt_pk_bf16_f32 v31, v74, v75
    buffer_store_dwordx4 v[28:31], v5, s[48:51], s8 offen sc1
    s_add_u32 s8, s8, 32768
    s_waitcnt lgkmcnt(0)
    v_pk_fma_f32 v[76:77], v[76:77], v[136:137], v[144:145]
    v_pk_fma_f32 v[78:79], v[78:79], v[138:139], v[146:147]
    v_pk_fma_f32 v[80:81], v[80:81], v[140:141], v[148:149]
    v_pk_fma_f32 v[82:83], v[82:83], v[142:143], v[150:151]
    v_cvt_pk_bf16_f32 v32, v76, v77
    v_cvt_pk_bf16_f32 v33, v78, v79
    v_cvt_pk_bf16_f32 v34, v80, v81
    v_cvt_pk_bf16_f32 v35, v82, v83
    buffer_store_dwordx4 v[32:35], v5, s[48:51], s8 offen sc1
    s_branch ph1__fin
ph1_bar:
    s_barrier
ph1_fin:
    s_waitcnt lgkmcnt(0)
    s_add_u32 s3, s3, 0x9e3779b1
ph1__fin:
    s_waitcnt vmcnt(0) lgkmcnt(0)
ph1__now:
    s_barrier
    s_cmp_lg_u32 s6, 0
    s_cbranch_scc1 Lfw_14
    s_cmp_lt_i32 s93, 0
    s_cbranch_scc1 Lfw_14
    v_mov_b32 v6, s3
    v_mov_b32 v7, 2304
    v_mul_u32_u24 v7, v7, v1
    s_bfm_b64 exec, s100, 0
    s_cmp_eq_u32 s100, 64
    s_cselect_b64 exec, -1, exec
    buffer_store_dword v6, v7, s[56:59], s93 offen sc1
    s_mov_b64 exec, -1
Lfw_14:
    s_mov_b32 s100, 32
    s_cmp_lt_u32 s5, 5
    s_cbranch_scc1 k2_side
    s_add_u32 s40, s38, 0
    s_addc_u32 s41, s39, 0
    s_mov_b32 s42, 1179648
    s_mov_b32 s43, 0x20000
    s_mov_b32 s44, s22
    s_mov_b32 s45, s23
    s_mov_b32 s46, 7962624
    s_mov_b32 s47, 0x20000
    s_add_u32 s48, s38, 1179648
    s_addc_u32 s49, s39, 0
    s_mov_b32 s50, 3538944
    s_mov_b32 s51, 0x20000
    s_mul_i32 s7, s4, 27
    s_add_u32 s7, s7, s5
    s_sub_u32 s7, s7, 5
    s_and_b32 s8, s7, 3
    s_lshr_b32 s9, s7, 2
    s_lshr_b32 s10, s8, 1
    s_mul_i32 s10, s10, 73216
    s_lshl_b32 s11, s8, 8
    s_add_u32 s10, s10, s11
    s_lshl_b32 s11, s9, 2
    s_add_u32 s10, s10, s11
    s_add_u32 s93, s10, 768
    s_lshl_b32 s15, s8, 7
    s_add_u32 s15, s15, s101
    s_lshl_b32 s10, s8, 13
    s_lshl_b32 s11, s9, 7
    s_lshl_b32 s12, s9, 16
    s_add_u32 s12, s12, s10
    s_cmp_lt_u32 s6, 4
    s_cbranch_scc1 Lcomp_15
    s_sub_u32 s74, s6, 4
    s_lshl_b32 s68, s74, 3
    v_lshrrev_b32 v6, 3, v1
    v_add_u32 v6, s68, v6
    v_and_b32 v7, 7, v1
    v_and_b32 v8, 2, v6
    v_bfe_u32 v9, v6, 3, 1
    v_lshl_or_b32 v8, v9, 2, v8
    v_xor_b32 v7, v7, v8
    s_movk_i32 s68, 6912
    v_mul_u32_u24 v6, s68, v6
    v_lshl_add_u32 v10, v7, 4, v6
    v_add_u32 v10, s11, v10
    v_add_u32 v11, 221184, v10
    s_lshr_b32 s68, s74, 1
    s_mul_i32 s68, s68, 32768
    s_and_b32 s69, s74, 1
    s_mul_i32 s69, s69, 4096
    s_add_u32 s68, s68, s69
    s_add_u32 s68, s68, s10
    v_lshl_add_u32 v12, v1, 4, s68
    s_mul_i32 s65, s74, 4096
    s_mul_i32 s66, s74, 1024
    s_add_u32 s66, s66, 16384
    s_mov_b32 s61, 0
    s_mov_b32 s62, 0
    s_add_u32 s67, s65, 147456
    s_mov_b32 s60, 0
Lpr_18:
    s_mov_b32 m0, s66
    s_nop 0
    buffer_load_dwordx4 v10, s[44:47], s62 offen lds
    s_add_u32 m0, s66, 4096
    s_nop 0
    buffer_load_dwordx4 v11, s[44:47], s62 offen lds
    s_add_u32 s62, s62, 442368
    s_add_u32 s66, s66, 24576
    s_add_u32 s60, s60, 1
    s_cmp_lt_u32 s60, 5
    s_cbranch_scc1 Lpr_18
    s_barrier
    s_mov_b32 s60, 0
Lpr_19:
    s_mov_b32 m0, s65
    s_nop 0
    buffer_load_dwordx4 v12, s[40:43], s61 offen lds
    buffer_load_dwordx4 v12, s[40:43], s61 offen offset:1024 lds
    buffer_load_dwordx4 v12, s[40:43], s61 offen offset:2048 lds
    buffer_load_dwordx4 v12, s[40:43], s61 offen offset:3072 lds
    s_add_u32 s61, s61, 65536
    s_add_u32 s65, s65, 24576
    s_add_u32 s60, s60, 1
    s_cmp_lt_u32 s60, 5
    s_cbranch_scc1 Lpr_19
Lld_16:
    s_cmp_ge_u32 s60, 9
    s_cbranch_scc1 Llsk_17s
    s_cmp_lg_u32 s60, 5
    s_cbranch_scc1 Llsk_170
    s_waitcnt vmcnt(16)
    s_branch Llsk_17
Llsk_170:
    s_cmp_lg_u32 s60, 6
    s_cbranch_scc1 Llsk_171
    s_waitcnt vmcnt(18)
    s_branch Llsk_17
Llsk_171:
    s_cmp_lg_u32 s60, 7
    s_cbranch_scc1 Llsk_172
    s_waitcnt vmcnt(20)
    s_branch Llsk_17
Llsk_172:
    s_waitcnt vmcnt(22)
    s_branch Llsk_17
Llsk_173:
Llsk_17s:
    s_waitcnt vmcnt(24)
Llsk_17:
    s_barrier
    s_mov_b32 m0, s66
    s_nop 0
    buffer_load_dwordx4 v10, s[44:47], s62 offen lds
    s_add_u32 m0, s66, 4096
    s_nop 0
    buffer_load_dwordx4 v11, s[44:47], s62 offen lds
    s_mov_b32 m0, s65
    s_nop 0
    buffer_load_dwordx4 v12, s[40:43], s61 offen lds
    buffer_load_dwordx4 v12, s[40:43], s61 offen offset:1024 lds
    buffer_load_dwordx4 v12, s[40:43], s61 offen offset:2048 lds
    buffer_load_dwordx4 v12, s[40:43], s61 offen offset:3072 lds
    s_add_u32 s61, s61, 65536
    s_add_u32 s65, s65, 24576
    s_add_u32 s62, s62, 442368
    s_add_u32 s66, s66, 24576
    s_cmp_eq_u32 s65, s67
    s_cselect_b32 s68, 147456, 0
    s_sub_u32 s65, s65, s68
    s_sub_u32 s66, s66, s68
    s_add_u32 s60, s60, 1
    s_cmp_lt_u32 s60, 18
    s_cbranch_scc1 Lld_16
    s_lshl_b32 s13, s7, 2
    s_add_u32 s13, s13, s74
    s_lshl_b32 s12, s5, 2
    s_add_u32 s12, s12, s74
    s_sub_u32 s12, s12, 20
    s_mov_b32 s76, s24
    s_mov_b32 s77, s25
    s_mov_b32 s78, 2654208
    s_mov_b32 s79, 0x20000
    s_lshl_b32 s14, s13, 10
    s_add_u32 s14, s14, 0
    v_add_u32 v13, s14, v5
    buffer_load_dwordx4 v[252:255], v13, s[76:79], 0 offen
    v_add_u32 v13, 884736, v13
    buffer_load_dwordx4 v[252:255], v13, s[76:79], 0 offen
    v_add_u32 v13, 884736, v13
    buffer_load_dwordx4 v[252:255], v13, s[76:79], 0 offen
    s_mov_b32 s76, s30
    s_mov_b32 s77, s31
    s_mov_b32 s78, 2654208
    s_mov_b32 s79, 0x20000
    s_lshl_b32 s14, s13, 10
    s_add_u32 s14, s14, 0
    v_add_u32 v13, s14, v5
    buffer_load_dwordx4 v[252:255], v13, s[76:79], 0 offen
    v_add_u32 v13, 884736, v13
    buffer_load_dwordx4 v[252:255], v13, s[76:79], 0 offen
    v_add_u32 v13, 884736, v13
    buffer_load_dwordx4 v[252:255], v13, s[76:79], 0 offen
    s_waitcnt vmcnt(30)
    s_barrier
    s_waitcnt vmcnt(24)
    s_barrier
    s_waitcnt vmcnt(18)
    s_barrier
    s_waitcnt vmcnt(12)
    s_barrier
    s_waitcnt vmcnt(6)
    s_barrier
    s_barrier
    s_branch ph2_now
Lcomp_15:
    v_and_b32 v10, 7, v1
    v_lshlrev_b32 v10, 2, v10
    s_cmp_lg_u32 s6, 1
    s_cbranch_scc1 Ldp_20
    buffer_load_dword v11, v10, s[56:59], s15 offen sc1
Ldp_20:
    s_lshr_b32 s70, s6, 1
    s_and_b32 s71, s6, 1
    s_mul_i32 s72, s70, 4096
    s_add_u32 s72, s72, 0
    v_lshl_add_u32 v14, v1, 4, s72
    v_lshrrev_b32 v6, 2, v2
    v_lshl_add_u32 v7, v3, 3, v6
    v_lshlrev_b32 v7, 7, v7
    v_and_b32 v8, 1, v2
    v_lshl_add_u32 v7, v8, 3, v7
    v_add_u32 v7, 16384, v7
    v_and_b32 v8, 1, v3
    v_lshrrev_b32 v9, 3, v2
    v_lshl_or_b32 v8, v8, 1, v9
    v_lshlrev_b32 v8, 1, v8
    v_bfe_u32 v9, v2, 1, 1
    v_or_b32 v8, v8, v9
    s_mul_i32 s72, s71, 4
    s_add_u32 s72, s72, 0
    v_xor_b32 v9, s72, v8
    v_lshl_add_u32 v16, v9, 4, v7
    s_mul_i32 s72, s71, 4
    s_add_u32 s72, s72, 2
    v_xor_b32 v9, s72, v8
    v_lshl_add_u32 v17, v9, 4, v7
    v_mov_b32 v20, 0
    v_mov_b32 v21, 0
    v_mov_b32 v22, 0
    v_mov_b32 v23, 0
    v_mov_b32 v24, 0
    v_mov_b32 v25, 0
    v_mov_b32 v26, 0
    v_mov_b32 v27, 0
    v_mov_b32 v28, 0
    v_mov_b32 v29, 0
    v_mov_b32 v30, 0
    v_mov_b32 v31, 0
    v_mov_b32 v32, 0
    v_mov_b32 v33, 0
    v_mov_b32 v34, 0
    v_mov_b32 v35, 0
    v_mov_b32 v36, 0
    v_mov_b32 v37, 0
    v_mov_b32 v38, 0
    v_mov_b32 v39, 0
    v_mov_b32 v40, 0
    v_mov_b32 v41, 0
    v_mov_b32 v42, 0
    v_mov_b32 v43, 0
    v_mov_b32 v44, 0
    v_mov_b32 v45, 0
    v_mov_b32 v46, 0
    v_mov_b32 v47, 0
    v_mov_b32 v48, 0
    v_mov_b32 v49, 0
    v_mov_b32 v50, 0
    v_mov_b32 v51, 0
    s_mov_b32 s60, 0
    s_mov_b32 s64, 0
    v_add_u32 v15, s64, v14
    v_add_u32 v18, s64, v16
    v_add_u32 v19, s64, v17
    s_cmp_lg_u32 s6, 1
    s_cbranch_scc1 Ldp_20b
    s_mov_b32 s68, 0
    s_branch Lfp_21e
Lfp_21:
    buffer_load_dword v11, v10, s[56:59], s15 offen sc1
Lfp_21e:
    s_waitcnt vmcnt(0)
    v_cmp_ne_u32 vcc, s3, v11
    s_add_u32 s68, s68, 1
    s_cmp_ge_u32 s68, 32768
    s_cbranch_scc1 Lfp_21x
    s_cbranch_vccnz Lfp_21
Lfp_21x:
Ldp_20b:
    s_barrier
    s_barrier
    ds_read_b128 v[52:55], v15 offset:0
    ds_read_b64_tr_b16 v[84:85], v18 offset:0
    ds_read_b64_tr_b16 v[86:87], v18 offset:512
    ds_read_b64_tr_b16 v[88:89], v19 offset:0
    ds_read_b64_tr_b16 v[90:91], v19 offset:512
    ds_read_b128 v[56:59], v15 offset:1024
    ds_read_b128 v[60:63], v15 offset:2048
    ds_read_b128 v[64:67], v15 offset:3072
Lk_22:
    s_add_u32 s64, s64, 24576
    s_cmp_eq_u32 s64, 147456
    s_cselect_b32 s64, 0, s64
    s_add_u32 s60, s60, 1
    s_waitcnt lgkmcnt(0)
    v_mfma_f32_16x16x32_bf16 v[20:23], v[84:87], v[52:55], v[20:23]
    ds_read_b128 v[68:71], v15 offset:8192
    ds_read_b64_tr_b16 v[92:93], v18 offset:4096
    v_mfma_f32_16x16x32_bf16 v[24:27], v[88:91], v[52:55], v[24:27]
    ds_read_b64_tr_b16 v[94:95], v18 offset:4608
    ds_read_b64_tr_b16 v[96:97], v19 offset:4096
    v_mfma_f32_16x16x32_bf16 v[28:31], v[84:87], v[56:59], v[28:31]
    ds_read_b64_tr_b16 v[98:99], v19 offset:4608
    ds_read_b128 v[72:75], v15 offset:9216
    v_mfma_f32_16x16x32_bf16 v[32:35], v[88:91], v[56:59], v[32:35]
    ds_read_b128 v[76:79], v15 offset:10240
    ds_read_b128 v[80:83], v15 offset:11264
    v_add_u32 v15, s64, v14
    v_mfma_f32_16x16x32_bf16 v[36:39], v[84:87], v[60:63], v[36:39]
    v_add_u32 v18, s64, v16
    v_mfma_f32_16x16x32_bf16 v[40:43], v[88:91], v[60:63], v[40:43]
    v_add_u32 v19, s64, v17
    v_mfma_f32_16x16x32_bf16 v[44:47], v[84:87], v[64:67], v[44:47]
    v_mfma_f32_16x16x32_bf16 v[48:51], v[88:91], v[64:67], v[48:51]
    s_cmp_lt_u32 s60, 18
    s_waitcnt lgkmcnt(0)
    s_barrier
    v_mfma_f32_16x16x32_bf16 v[20:23], v[92:95], v[68:71], v[20:23]
    ds_read_b128 v[52:55], v15 offset:0
    ds_read_b64_tr_b16 v[84:85], v18 offset:0
    v_mfma_f32_16x16x32_bf16 v[24:27], v[96:99], v[68:71], v[24:27]
    ds_read_b64_tr_b16 v[86:87], v18 offset:512
    ds_read_b64_tr_b16 v[88:89], v19 offset:0
    v_mfma_f32_16x16x32_bf16 v[28:31], v[92:95], v[72:75], v[28:31]
    ds_read_b64_tr_b16 v[90:91], v19 offset:512
    ds_read_b128 v[56:59], v15 offset:1024
    v_mfma_f32_16x16x32_bf16 v[32:35], v[96:99], v[72:75], v[32:35]
    ds_read_b128 v[60:63], v15 offset:2048
    ds_read_b128 v[64:67], v15 offset:3072
    v_mfma_f32_16x16x32_bf16 v[36:39], v[92:95], v[76:79], v[36:39]
    v_mfma_f32_16x16x32_bf16 v[40:43], v[96:99], v[76:79], v[40:43]
    v_mfma_f32_16x16x32_bf16 v[44:47], v[92:95], v[80:83], v[44:47]
    v_mfma_f32_16x16x32_bf16 v[48:51], v[96:99], v[80:83], v[48:51]
    s_cbranch_scc1 Lk_22
    s_waitcnt lgkmcnt(0)
    s_nop 6
    s_lshl_b32 s72, s70, 12
    s_lshl_b32 s73, s71, 15
    s_add_u32 s72, s72, s73
    s_add_u32 s72, s72, s12
    v_cvt_pk_bf16_f32 v20, v20, v21
    v_cvt_pk_bf16_f32 v21, v22, v23
    v_cvt_pk_bf16_f32 v22, v24, v25
    v_cvt_pk_bf16_f32 v23, v26, v27
    buffer_store_dwordx4 v[20:23], v5, s[48:51], s72 offen offset:0 sc1
    v_cvt_pk_bf16_f32 v28, v28, v29
    v_cvt_pk_bf16_f32 v29, v30, v31
    v_cvt_pk_bf16_f32 v30, v32, v33
    v_cvt_pk_bf16_f32 v31, v34, v35
    buffer_store_dwordx4 v[28:31], v5, s[48:51], s72 offen offset:1024 sc1
    v_cvt_pk_bf16_f32 v36, v36, v37
    v_cvt_pk_bf16_f32 v37, v38, v39
    v_cvt_pk_bf16_f32 v38, v40, v41
    v_cvt_pk_bf16_f32 v39, v42, v43
    buffer_store_dwordx4 v[36:39], v5, s[48:51], s72 offen offset:2048 sc1
    v_cvt_pk_bf16_f32 v44, v44, v45
    v_cvt_pk_bf16_f32 v45, v46, v47
    v_cvt_pk_bf16_f32 v46, v48, v49
    v_cvt_pk_bf16_f32 v47, v50, v51
    buffer_store_dwordx4 v[44:47], v5, s[48:51], s72 offen offset:3072 sc1
    s_branch ph2_fin
k2_side:
    s_mul_i32 s7, s4, 5
    s_add_u32 s7, s7, s5
    s_and_b32 s8, s7, 1
    s_lshr_b32 s9, s7, 1
    s_mul_i32 s10, s8, 73728
    s_lshl_b32 s11, s9, 2
    s_add_u32 s10, s10, s11
    s_add_u32 s93, s10, 640
    s_add_u32 s9, s9, 16
    s_mov_b32 s40, s20
    s_mov_b32 s41, s21
    s_mov_b32 s42, 354816
    s_mov_b32 s43, 0x20000
    s_mov_b32 s44, s28
    s_mov_b32 s45, s29
    s_mov_b32 s46, 5308416
    s_mov_b32 s47, 0x20000
    s_add_u32 s48, s38, 4718592
    s_addc_u32 s49, s39, 0
    s_mov_b32 s50, 737280
    s_mov_b32 s51, 0x20000
    s_mul_i32 s10, s8, 177408
    s_lshl_b32 s11, s9, 7
    s_mul_i32 s12, s9, 20480
    s_mul_i32 s13, s8, 2560
    s_add_u32 s12, s12, s13
    s_cmp_lt_u32 s6, 4
    s_cbranch_scc1 Lcomp_23
    s_sub_u32 s74, s6, 4
    s_lshl_b32 s68, s74, 3
    v_lshrrev_b32 v6, 3, v1
    v_add_u32 v6, s68, v6
    v_and_b32 v7, 7, v1
    v_and_b32 v8, 2, v6
    v_bfe_u32 v9, v6, 3, 1
    v_lshl_or_b32 v8, v9, 2, v8
    v_xor_b32 v7, v7, v8
    s_movk_i32 s68, 4608
    v_mul_u32_u24 v6, s68, v6
    v_lshl_add_u32 v10, v7, 4, v6
    v_add_u32 v10, s11, v10
    v_add_u32 v11, 147456, v10
    s_mul_i32 s68, s74, 20
    v_lshrrev_b32 v6, 3, v1
    v_add_u32 v6, s68, v6
    v_and_b32 v7, 7, v1
    v_add_u32 v8, 0, v6
    v_bfe_u32 v9, v8, 1, 3
    v_xor_b32 v9, v9, v7
    s_movk_i32 s68, 2304
    v_mul_u32_u24 v8, s68, v8
    v_lshl_add_u32 v12, v9, 4, v8
    v_add_u32 v12, s10, v12
    v_add_u32 v8, 8, v6
    v_bfe_u32 v9, v8, 1, 3
    v_xor_b32 v9, v9, v7
    s_movk_i32 s68, 2304
    v_mul_u32_u24 v8, s68, v8
    v_lshl_add_u32 v13, v9, 4, v8
    v_add_u32 v13, s10, v13
    v_add_u32 v14, 36864, v12
    s_mul_i32 s65, s74, 2560
    s_mul_i32 s66, s74, 1024
    s_add_u32 s66, s66, 10240
    s_mov_b32 s61, 0
    s_mov_b32 s62, 0
    s_add_u32 s67, s65, 147456
    s_mov_b32 s60, 0
Lpr_26:
    s_mov_b32 m0, s66
    s_nop 0
    buffer_load_dwordx4 v10, s[44:47], s62 offen lds
    s_add_u32 m0, s66, 4096
    s_nop 0
    buffer_load_dwordx4 v11, s[44:47], s62 offen lds
    s_mov_b32 m0, s65
    s_nop 0
    buffer_load_dwordx4 v12, s[40:43], s61 offen lds
    s_add_u32 m0, s65, 1024
    s_nop 0
    buffer_load_dwordx4 v13, s[40:43], s61 offen lds
    s_add_u32 m0, s65, 2048
    s_mov_b32 exec_hi, 0
    buffer_load_dwordx4 v14, s[40:43], s61 offen lds
    s_mov_b32 exec_hi, -1
    s_add_u32 s61, s61, 128
    s_add_u32 s65, s65, 18432
    s_add_u32 s62, s62, 294912
    s_add_u32 s66, s66, 18432
    s_add_u32 s60, s60, 1
    s_cmp_lt_u32 s60, 7
    s_cbranch_scc1 Lpr_26
Lld_24:
    s_waitcnt vmcnt(30)
Llsk_25:
    s_barrier
    s_mov_b32 m0, s66
    s_nop 0
    buffer_load_dwordx4 v10, s[44:47], s62 offen lds
    s_add_u32 m0, s66, 4096
    s_nop 0
    buffer_load_dwordx4 v11, s[44:47], s62 offen lds
    s_mov_b32 m0, s65
    s_nop 0
    buffer_load_dwordx4 v12, s[40:43], s61 offen lds
    s_add_u32 m0, s65, 1024
    s_nop 0
    buffer_load_dwordx4 v13, s[40:43], s61 offen lds
    s_add_u32 m0, s65, 2048
    s_mov_b32 exec_hi, 0
    buffer_load_dwordx4 v14, s[40:43], s61 offen lds
    s_mov_b32 exec_hi, -1
    s_add_u32 s61, s61, 128
    s_add_u32 s65, s65, 18432
    s_add_u32 s62, s62, 294912
    s_add_u32 s66, s66, 18432
    s_cmp_eq_u32 s65, s67
    s_cselect_b32 s68, 147456, 0
    s_sub_u32 s65, s65, s68
    s_sub_u32 s66, s66, s68
    s_add_u32 s60, s60, 1
    s_cmp_lt_u32 s60, 18
    s_cbranch_scc1 Lld_24
    s_waitcnt vmcnt(30)
    s_barrier
    s_waitcnt vmcnt(25)
    s_barrier
    s_waitcnt vmcnt(20)
    s_barrier
    s_waitcnt vmcnt(15)
    s_barrier
    s_waitcnt vmcnt(10)
    s_barrier
    s_waitcnt vmcnt(5)
    s_barrier
    s_waitcnt vmcnt(0)
    s_barrier
    s_barrier
    s_branch ph2_now
Lcomp_23:
    s_mov_b32 s70, 0
    s_and_b32 s71, s6, 3
    v_bfe_u32 v6, v2, 1, 3
    v_xor_b32 v6, v6, v3
    v_lshlrev_b32 v6, 4, v6
    v_lshl_add_u32 v6, v2, 7, v6
    s_mul_i32 s72, s70, 10240
    s_add_u32 s72, s72, 0
    v_add_u32 v10, s72, v6
    v_xor_b32 v11, 64, v10
    v_lshrrev_b32 v6, 2, v2
    v_lshl_add_u32 v7, v3, 3, v6
    v_lshlrev_b32 v7, 7, v7
    v_and_b32 v8, 1, v2
    v_lshl_add_u32 v7, v8, 3, v7
    v_add_u32 v7, 10240, v7
    v_and_b32 v8, 1, v3
    v_lshrrev_b32 v9, 3, v2
    v_lshl_or_b32 v8, v8, 1, v9
    v_lshlrev_b32 v8, 1, v8
    v_bfe_u32 v9, v2, 1, 1
    v_or_b32 v8, v8, v9
    s_mul_i32 s72, s71, 2
    s_add_u32 s72, s72, 0
    v_xor_b32 v9, s72, v8
    v_lshl_add_u32 v14, v9, 4, v7
    v_mov_b32 v16, 0
    v_mov_b32 v17, 0
    v_mov_b32 v18, 0
    v_mov_b32 v19, 0
    v_mov_b32 v20, 0
    v_mov_b32 v21, 0
    v_mov_b32 v22, 0
    v_mov_b32 v23, 0
    v_mov_b32 v24, 0
    v_mov_b32 v25, 0
    v_mov_b32 v26, 0
    v_mov_b32 v27, 0
    v_mov_b32 v28, 0
    v_mov_b32 v29, 0
    v_mov_b32 v30, 0
    v_mov_b32 v31, 0
    v_mov_b32 v32, 0
    v_mov_b32 v33, 0
    v_mov_b32 v34, 0
    v_mov_b32 v35, 0
    s_mov_b32 s60, 0
    s_mov_b32 s64, 0
    v_add_u32 v12, s64, v10
    v_add_u32 v13, s64, v11
    v_add_u32 v15, s64, v14
    s_barrier
    ds_read_b128 v[36:39], v12 offset:0
    ds_read_b64_tr_b16 v[76:77], v15 offset:0
    ds_read_b64_tr_b16 v[78:79], v15 offset:512
    ds_read_b128 v[40:43], v12 offset:2048
    ds_read_b128 v[44:47], v12 offset:4096
    ds_read_b128 v[48:51], v12 offset:6144
    ds_read_b128 v[52:55], v12 offset:8192
Lk_27:
    s_add_u32 s64, s64, 18432
    s_cmp_eq_u32 s64, 147456
    s_cselect_b32 s64, 0, s64
    s_add_u32 s60, s60, 1
    s_waitcnt lgkmcnt(0)
    v_mfma_f32_16x16x32_bf16 v[16:19], v[76:79], v[36:39], v[16:19]
    ds_read_b128 v[56:59], v13 offset:0
    ds_read_b64_tr_b16 v[80:81], v15 offset:4096
    v_mfma_f32_16x16x32_bf16 v[20:23], v[76:79], v[40:43], v[20:23]
    ds_read_b64_tr_b16 v[82:83], v15 offset:4608
    ds_read_b128 v[60:63], v13 offset:2048
    v_mfma_f32_16x16x32_bf16 v[24:27], v[76:79], v[44:47], v[24:27]
    ds_read_b128 v[64:67], v13 offset:4096
    ds_read_b128 v[68:71], v13 offset:6144
    v_mfma_f32_16x16x32_bf16 v[28:31], v[76:79], v[48:51], v[28:31]
    ds_read_b128 v[72:75], v13 offset:8192
    v_add_u32 v12, s64, v10
    v_mfma_f32_16x16x32_bf16 v[32:35], v[76:79], v[52:55], v[32:35]
    v_add_u32 v13, s64, v11
    v_add_u32 v15, s64, v14
    s_cmp_lt_u32 s60, 18
    s_waitcnt lgkmcnt(0)
    s_barrier
    v_mfma_f32_16x16x32_bf16 v[16:19], v[80:83], v[56:59], v[16:19]
    ds_read_b128 v[36:39], v12 offset:0
    ds_read_b64_tr_b16 v[76:77], v15 offset:0
    v_mfma_f32_16x16x32_bf16 v[20:23], v[80:83], v[60:63], v[20:23]
    ds_read_b64_tr_b16 v[78:79], v15 offset:512
    ds_read_b128 v[40:43], v12 offset:2048
    v_mfma_f32_16x16x32_bf16 v[24:27], v[80:83], v[64:67], v[24:27]
    ds_read_b128 v[44:47], v12 offset:4096
    ds_read_b128 v[48:51], v12 offset:6144
    v_mfma_f32_16x16x32_bf16 v[28:31], v[80:83], v[68:71], v[28:31]
    ds_read_b128 v[52:55], v12 offset:8192
    v_mfma_f32_16x16x32_bf16 v[32:35], v[80:83], v[72:75], v[32:35]
    s_cbranch_scc1 Lk_27
    s_waitcnt lgkmcnt(0)
    s_nop 6
    s_mul_i32 s72, s70, 2560
    s_mul_i32 s73, s71, 5120
    s_add_u32 s72, s72, s73
    s_add_u32 s72, s72, s12
    v_cvt_pk_bf16_f32 v16, v16, v17
    v_cvt_pk_bf16_f32 v17, v18, v19
    buffer_store_dwordx2 v[16:17], v4, s[48:51], s72 offen offset:0 sc1
    v_cvt_pk_bf16_f32 v20, v20, v21
    v_cvt_pk_bf16_f32 v21, v22, v23
    buffer_store_dwordx2 v[20:21], v4, s[48:51], s72 offen offset:512 sc1
    v_cvt_pk_bf16_f32 v24, v24, v25
    v_cvt_pk_bf16_f32 v25, v26, v27
    buffer_store_dwordx2 v[24:25], v4, s[48:51], s72 offen offset:1024 sc1
    v_cvt_pk_bf16_f32 v28, v28, v29
    v_cvt_pk_bf16_f32 v29, v30, v31
    buffer_store_dwordx2 v[28:29], v4, s[48:51], s72 offen offset:1536 sc1
    v_cvt_pk_bf16_f32 v32, v32, v33
    v_cvt_pk_bf16_f32 v33, v34, v35
    buffer_store_dwordx2 v[32:33], v4, s[48:51], s72 offen offset:2048 sc1
    s_branch ph2_fin
ph2_fin:
    s_waitcnt vmcnt(0) lgkmcnt(0)
ph2_now:
    s_barrier
    s_cmp_lg_u32 s6, 0
    s_cbranch_scc1 Lfw_28
    s_cmp_lt_i32 s93, 0
    s_cbranch_scc1 Lfw_28
    v_mov_b32 v6, s3
    v_mov_b32 v7, 2304
    v_mul_u32_u24 v7, v7, v1
    s_bfm_b64 exec, s100, 0
    s_cmp_eq_u32 s100, 64
    s_cselect_b64 exec, -1, exec
    buffer_store_dword v6, v7, s[56:59], s93 offen sc1
    s_mov_b64 exec, -1
Lfw_28:
    s_lshr_b32 s14, s4, 2
    s_and_b32 s15, s4, 3
    s_mul_i32 s10, s14, 73728
    s_lshl_b32 s11, s15, 7
    s_add_u32 s10, s10, s11
    s_lshl_b32 s11, s5, 2
    s_add_u32 s10, s10, s11
    s_add_u32 s93, s10, 1280
    s_cmp_lt_u32 s5, 9
    s_cbranch_scc1 k3_ab
    s_cmp_ge_u32 s5, 27
    s_cbranch_scc1 k3_s
    s_add_u32 s40, s38, 1179648
    s_addc_u32 s41, s39, 0
    s_mov_b32 s42, 3538944
    s_mov_b32 s43, 0x20000
    s_mov_b32 s44, s24
    s_mov_b32 s45, s25
    s_mov_b32 s46, 2654208
    s_mov_b32 s47, 0x20000
    s_add_u32 s48, s38, 6291456
    s_addc_u32 s49, s39, 0
    s_mov_b32 s50, 1179648
    s_mov_b32 s51, 0x20000
    s_mul_i32 s7, s15, 18
    s_add_u32 s7, s7, s5
    s_sub_u32 s7, s7, 9
    s_and_b32 s8, s7, 3
    s_lshr_b32 s9, s7, 2
    s_lshr_b32 s13, s8, 1
    s_lshl_b32 s13, s13, 8
    s_add_u32 s94, s101, s13
    s_add_u32 s94, s94, 912
    s_lshl_b32 s10, s14, 14
    s_lshl_b32 s13, s8, 12
    s_add_u32 s10, s10, s13
    s_add_u32 s10, s10, 2359296
    s_lshl_b32 s11, s9, 7
    s_mul_i32 s12, s14, 589824
    s_mul_i32 s13, s8, 147456
    s_add_u32 s12, s12, s13
    s_lshl_b32 s13, s9, 12
    s_add_u32 s12, s12, s13
    s_cmp_lt_u32 s6, 4
    s_cbranch_scc1 Lcomp_29
    s_sub_u32 s74, s6, 4
    s_lshl_b32 s68, s74, 3
    v_lshrrev_b32 v6, 3, v1
    v_add_u32 v6, s68, v6
    v_and_b32 v7, 7, v1
    v_and_b32 v8, 6, v6
    v_xor_b32 v7, v7, v8
    s_movk_i32 s68, 2304
    v_mul_u32_u24 v6, s68, v6
    v_lshl_add_u32 v10, v7, 4, v6
    v_add_u32 v10, s11, v10
    v_add_u32 v11, 73728, v10
    s_lshr_b32 s68, s74, 1
    s_mul_i32 s68, s68, 32768
    s_and_b32 s69, s74, 1
    s_mul_i32 s69, s69, 2048
    s_add_u32 s68, s68, s69
    s_add_u32 s68, s68, s10
    v_lshl_add_u32 v12, v1, 4, s68
    s_mul_i32 s65, s74, 2048
    s_mul_i32 s66, s74, 1024
    s_add_u32 s66, s66, 8192
    s_mov_b32 s61, 0
    s_mov_b32 s62, 0
    s_add_u32 s67, s65, 147456
    s_mov_b32 s60, 0
Lpr_32:
    s_mov_b32 m0, s66
    s_nop 0
    buffer_load_dwordx4 v10, s[44:47], s62 offen lds
    s_add_u32 m0, s66, 4096
    s_nop 0
    buffer_load_dwordx4 v11, s[44:47], s62 offen lds
    s_add_u32 s62, s62, 147456
    s_add_u32 s66, s66, 16384
    s_add_u32 s60, s60, 1
    s_cmp_lt_u32 s60, 8
    s_cbranch_scc1 Lpr_32
    s_barrier
    s_mov_b32 s60, 0
Lpr_33:
    s_mov_b32 m0, s65
    s_nop 0
    buffer_load_dwordx4 v12, s[40:43], s61 offen lds
    buffer_load_dwordx4 v12, s[40:43], s61 offen offset:1024 lds
    s_add_u32 s61, s61, 65536
    s_add_u32 s65, s65, 16384
    s_add_u32 s60, s60, 1
    s_cmp_lt_u32 s60, 8
    s_cbranch_scc1 Lpr_33
Lld_30:
    s_cmp_ge_u32 s60, 15
    s_cbranch_scc1 Llsk_31s
    s_cmp_lg_u32 s60, 8
    s_cbranch_scc1 Llsk_310
    s_waitcnt vmcnt(14)
    s_branch Llsk_31
Llsk_310:
    s_cmp_lg_u32 s60, 9
    s_cbranch_scc1 Llsk_311
    s_waitcnt vmcnt(16)
    s_branch Llsk_31
Llsk_311:
    s_cmp_lg_u32 s60, 10
    s_cbranch_scc1 Llsk_312
    s_waitcnt vmcnt(18)
    s_branch Llsk_31
Llsk_312:
    s_cmp_lg_u32 s60, 11
    s_cbranch_scc1 Llsk_313
    s_waitcnt vmcnt(20)
    s_branch Llsk_31
Llsk_313:
    s_cmp_lg_u32 s60, 12
    s_cbranch_scc1 Llsk_314
    s_waitcnt vmcnt(22)
    s_branch Llsk_31
Llsk_314:
    s_cmp_lg_u32 s60, 13
    s_cbranch_scc1 Llsk_315
    s_waitcnt vmcnt(24)
    s_branch Llsk_31
Llsk_315:
    s_waitcnt vmcnt(26)
    s_branch Llsk_31
Llsk_316:
Llsk_31s:
    s_waitcnt vmcnt(28)
Llsk_31:
    s_barrier
    s_mov_b32 m0, s66
    s_nop 0
    buffer_load_dwordx4 v10, s[44:47], s62 offen lds
    s_add_u32 m0, s66, 4096
    s_nop 0
    buffer_load_dwordx4 v11, s[44:47], s62 offen lds
    s_mov_b32 m0, s65
    s_nop 0
    buffer_load_dwordx4 v12, s[40:43], s61 offen lds
    buffer_load_dwordx4 v12, s[40:43], s61 offen offset:1024 lds
    s_add_u32 s61, s61, 65536
    s_add_u32 s65, s65, 16384
    s_add_u32 s62, s62, 147456
    s_add_u32 s66, s66, 16384
    s_cmp_eq_u32 s65, s67
    s_cselect_b32 s68, 147456, 0
    s_sub_u32 s65, s65, s68
    s_sub_u32 s66, s66, s68
    s_add_u32 s60, s60, 1
    s_cmp_lt_u32 s60, 18
    s_cbranch_scc1 Lld_30
    s_waitcnt vmcnt(28)
    s_barrier
    s_waitcnt vmcnt(24)
    s_barrier
    s_waitcnt vmcnt(20)
    s_barrier
    s_waitcnt vmcnt(16)
    s_barrier
    s_waitcnt vmcnt(12)
    s_barrier
    s_waitcnt vmcnt(8)
    s_barrier
    s_waitcnt vmcnt(4)
    s_barrier
    s_waitcnt vmcnt(0)
    s_barrier
    s_barrier
    s_branch ph3_now
Lcomp_29:
    v_min_u32 v10, 17, v1
    v_lshlrev_b32 v10, 2, v10
    s_cmp_lg_u32 s6, 1
    s_cbranch_scc1 Ldp_34
    buffer_load_dword v11, v10, s[56:59], s94 offen sc1
Ldp_34:
    s_lshr_b32 s70, s6, 1
    s_and_b32 s71, s6, 1
    s_mul_i32 s72, s70, 2048
    s_add_u32 s72, s72, 0
    v_lshl_add_u32 v14, v1, 4, s72
    v_lshrrev_b32 v6, 2, v2
    v_lshl_add_u32 v7, v3, 2, v6
    v_lshlrev_b32 v7, 7, v7
    v_and_b32 v8, 1, v2
    v_lshl_add_u32 v7, v8, 3, v7
    v_add_u32 v7, 8192, v7
    v_and_b32 v8, 1, v3
    v_lshrrev_b32 v9, 3, v2
    v_lshl_or_b32 v8, v8, 1, v9
    v_lshlrev_b32 v8, 1, v8
    v_bfe_u32 v9, v2, 1, 1
    v_or_b32 v8, v8, v9
    s_mul_i32 s72, s71, 4
    s_add_u32 s72, s72, 0
    v_xor_b32 v9, s72, v8
    v_lshl_add_u32 v16, v9, 4, v7
    s_mul_i32 s72, s71, 4
    s_add_u32 s72, s72, 2
    v_xor_b32 v9, s72, v8
    v_lshl_add_u32 v17, v9, 4, v7
    v_mov_b32 v20, 0
    v_mov_b32 v21, 0
    v_mov_b32 v22, 0
    v_mov_b32 v23, 0
    v_mov_b32 v24, 0
    v_mov_b32 v25, 0
    v_mov_b32 v26, 0
    v_mov_b32 v27, 0
    v_mov_b32 v28, 0
    v_mov_b32 v29, 0
    v_mov_b32 v30, 0
    v_mov_b32 v31, 0
    v_mov_b32 v32, 0
    v_mov_b32 v33, 0
    v_mov_b32 v34, 0
    v_mov_b32 v35, 0
    s_mov_b32 s60, 0
    s_mov_b32 s64, 0
    v_add_u32 v15, s64, v14
    v_add_u32 v18, s64, v16
    v_add_u32 v19, s64, v17
    s_cmp_lg_u32 s6, 1
    s_cbranch_scc1 Ldp_34b
    s_mov_b32 s68, 0
    s_branch Lfp_35e
Lfp_35:
    buffer_load_dword v11, v10, s[56:59], s94 offen sc1
Lfp_35e:
    s_waitcnt vmcnt(0)
    v_cmp_ne_u32 vcc, s3, v11
    s_add_u32 s68, s68, 1
    s_cmp_ge_u32 s68, 32768
    s_cbranch_scc1 Lfp_35x
    s_cbranch_vccnz Lfp_35
Lfp_35x:
Ldp_34b:
    s_barrier
    s_barrier
    ds_read_b128 v[36:39], v15 offset:0
    ds_read_b64_tr_b16 v[52:53], v18 offset:0
    ds_read_b64_tr_b16 v[54:55], v18 offset:2048
    ds_read_b64_tr_b16 v[56:57], v19 offset:0
    ds_read_b64_tr_b16 v[58:59], v19 offset:2048
    ds_read_b128 v[40:43], v15 offset:1024
Lk_36:
    s_add_u32 s64, s64, 16384
    s_cmp_eq_u32 s64, 147456
    s_cselect_b32 s64, 0, s64
    s_add_u32 s60, s60, 1
    s_waitcnt lgkmcnt(0)
    v_mfma_f32_16x16x32_bf16 v[20:23], v[36:39], v[52:55], v[20:23]
    ds_read_b128 v[44:47], v15 offset:4096
    ds_read_b64_tr_b16 v[60:61], v18 offset:4096
    v_mfma_f32_16x16x32_bf16 v[24:27], v[36:39], v[56:59], v[24:27]
    ds_read_b64_tr_b16 v[62:63], v18 offset:6144
    ds_read_b64_tr_b16 v[64:65], v19 offset:4096
    v_mfma_f32_16x16x32_bf16 v[28:31], v[40:43], v[52:55], v[28:31]
    ds_read_b64_tr_b16 v[66:67], v19 offset:6144
    ds_read_b128 v[48:51], v15 offset:5120
    v_add_u32 v15, s64, v14
    v_mfma_f32_16x16x32_bf16 v[32:35], v[40:43], v[56:59], v[32:35]
    v_add_u32 v18, s64, v16
    v_add_u32 v19, s64, v17
    s_cmp_lt_u32 s60, 18
    s_waitcnt lgkmcnt(0)
    s_barrier
    v_mfma_f32_16x16x32_bf16 v[20:23], v[44:47], v[60:63], v[20:23]
    ds_read_b128 v[36:39], v15 offset:0
    ds_read_b64_tr_b16 v[52:53], v18 offset:0
    v_mfma_f32_16x16x32_bf16 v[24:27], v[44:47], v[64:67], v[24:27]
    ds_read_b64_tr_b16 v[54:55], v18 offset:2048
    ds_read_b64_tr_b16 v[56:57], v19 offset:0
    v_mfma_f32_16x16x32_bf16 v[28:31], v[48:51], v[60:63], v[28:31]
    ds_read_b64_tr_b16 v[58:59], v19 offset:2048
    ds_read_b128 v[40:43], v15 offset:1024
    v_mfma_f32_16x16x32_bf16 v[32:35], v[48:51], v[64:67], v[32:35]
    s_cbranch_scc1 Lk_36
    s_waitcnt lgkmcnt(0)
    s_nop 6
    s_mul_i32 s72, s70, 73728
    s_lshl_b32 s73, s71, 11
    s_add_u32 s72, s72, s73
    s_add_u32 s72, s72, s12
    v_cvt_pk_bf16_f32 v20, v20, v21
    v_cvt_pk_bf16_f32 v21, v22, v23
    v_cvt_pk_bf16_f32 v22, v28, v29
    v_cvt_pk_bf16_f32 v23, v30, v31
    buffer_store_dwordx4 v[20:23], v5, s[48:51], s72 offen offset:0 sc1
    v_cvt_pk_bf16_f32 v24, v24, v25
    v_cvt_pk_bf16_f32 v25, v26, v27
    v_cvt_pk_bf16_f32 v26, v32, v33
    v_cvt_pk_bf16_f32 v27, v34, v35
    buffer_store_dwordx4 v[24:27], v5, s[48:51], s72 offen offset:1024 sc1
    s_branch ph3_fin
k3_s:
    s_cmp_ge_u32 s5, 31
    s_cbranch_scc1 k3_misc
    s_add_u32 s40, s38, 1179648
    s_addc_u32 s41, s39, 0
    s_mov_b32 s42, 3538944
    s_mov_b32 s43, 0x20000
    s_add_u32 s44, s38, 1179648
    s_addc_u32 s45, s39, 0
    s_mov_b32 s46, 3538944
    s_mov_b32 s47, 0x20000
    s_add_u32 s48, s38, 7471104
    s_addc_u32 s49, s39, 0
    s_mov_b32 s50, 294912
    s_mov_b32 s51, 0x20000
    s_sub_u32 s7, s5, 27
    s_and_b32 s8, s15, 2
    s_lshr_b32 s13, s7, 1
    s_add_u32 s8, s8, s13
    s_and_b32 s9, s15, 1
    s_lshl_b32 s9, s9, 1
    s_and_b32 s13, s7, 1
    s_add_u32 s9, s9, s13
    s_lshl_b32 s10, s14, 14
    s_lshl_b32 s13, s8, 12
    s_add_u32 s10, s10, s13
    s_lshl_b32 s11, s14, 14
    s_lshl_b32 s13, s9, 12
    s_add_u32 s11, s11, s13
    s_add_u32 s11, s11, 1179648
    s_add_u32 s95, s101, 768
    s_lshr_b32 s13, s8, 1
    s_lshl_b32 s13, s13, 8
    s_add_u32 s94, s95, s13
    s_lshr_b32 s13, s9, 1
    s_lshl_b32 s13, s13, 8
    s_add_u32 s95, s95, s13
    s_cmp_lt_u32 s6, 4
    s_cbranch_scc1 Lcomp_37
    s_sub_u32 s74, s6, 4
    s_lshr_b32 s68, s74, 1
    s_mul_i32 s68, s68, 32768
    s_and_b32 s69, s74, 1
    s_mul_i32 s69, s69, 2048
    s_add_u32 s68, s68, s69
    s_add_u32 s68, s68, s11
    v_lshl_add_u32 v10, v1, 4, s68
    s_lshr_b32 s68, s74, 1
    s_mul_i32 s68, s68, 32768
    s_and_b32 s69, s74, 1
    s_mul_i32 s69, s69, 2048
    s_add_u32 s68, s68, s69
    s_add_u32 s68, s68, s10
    v_lshl_add_u32 v11, v1, 4, s68
    s_mul_i32 s65, s74, 2048
    s_mul_i32 s66, s74, 2048
    s_add_u32 s66, s66, 8192
    s_mov_b32 s61, 0
    s_mov_b32 s62, 0
    s_add_u32 s67, s65, 65536
    s_barrier
    s_mov_b32 s60, 0
Lpr_40:
    s_mov_b32 m0, s66
    s_nop 0
    buffer_load_dwordx4 v10, s[44:47], s62 offen lds
    buffer_load_dwordx4 v10, s[44:47], s62 offen offset:1024 lds
    s_mov_b32 m0, s65
    s_nop 0
    buffer_load_dwordx4 v11, s[40:43], s61 offen lds
    buffer_load_dwordx4 v11, s[40:43], s61 offen offset:1024 lds
    s_add_u32 s61, s61, 65536
    s_add_u32 s65, s65, 16384
    s_add_u32 s62, s62, 65536
    s_add_u32 s66, s66, 16384
    s_add_u32 s60, s60, 1
    s_cmp_lt_u32 s60, 3
    s_cbranch_scc1 Lpr_40
Lld_38:
    s_waitcnt vmcnt(8)
Llsk_39:
    s_barrier
    s_mov_b32 m0, s66
    s_nop 0
    buffer_load_dwordx4 v10, s[44:47], s62 offen lds
    buffer_load_dwordx4 v10, s[44:47], s62 offen offset:1024 lds
    s_mov_b32 m0, s65
    s_nop 0
    buffer_load_dwordx4 v11, s[40:43], s61 offen lds
    buffer_load_dwordx4 v11, s[40:43], s61 offen offset:1024 lds
    s_add_u32 s61, s61, 65536
    s_add_u32 s65, s65, 16384
    s_add_u32 s62, s62, 65536
    s_add_u32 s66, s66, 16384
    s_cmp_eq_u32 s65, s67
    s_cselect_b32 s68, 65536, 0
    s_sub_u32 s65, s65, s68
    s_sub_u32 s66, s66, s68
    s_add_u32 s60, s60, 1
    s_cmp_lt_u32 s60, 18
    s_cbranch_scc1 Lld_38
    s_waitcnt vmcnt(8)
    s_barrier
    s_waitcnt vmcnt(4)
    s_barrier
    s_waitcnt vmcnt(0)
    s_barrier
    s_barrier
    s_branch ph3_now
Lcomp_37:
    v_min_u32 v10, 35, v1
    v_lshlrev_b32 v10, 2, v10
    v_cmp_gt_u32 vcc, 72, v10
    v_mov_b32 v11, s95
    v_add_u32 v11, v11, v10
    v_add_u32 v10, s94, v10
    v_cndmask_b32 v10, v11, v10, vcc
    s_cmp_lg_u32 s6, 1
    s_cbranch_scc1 Ldp_41
    buffer_load_dword v11, v10, s[56:59], 0 offen sc1
Ldp_41:
    s_lshr_b32 s70, s6, 1
    s_and_b32 s71, s6, 1
    s_mul_i32 s72, s70, 2048
    s_add_u32 s72, s72, 0
    v_lshl_add_u32 v14, v1, 4, s72
    s_mul_i32 s72, s71, 2048
    s_add_u32 s72, s72, 8192
    v_lshl_add_u32 v16, v1, 4, s72
    v_mov_b32 v20, 0
    v_mov_b32 v21, 0
    v_mov_b32 v22, 0
    v_mov_b32 v23, 0
    v_mov_b32 v24, 0
    v_mov_b32 v25, 0
    v_mov_b32 v26, 0
    v_mov_b32 v27, 0
    v_mov_b32 v28, 0
    v_mov_b32 v29, 0
    v_mov_b32 v30, 0
    v_mov_b32 v31, 0
    v_mov_b32 v32, 0
    v_mov_b32 v33, 0
    v_mov_b32 v34, 0
    v_mov_b32 v35, 0
    s_mov_b32 s60, 0
    s_mov_b32 s64, 0
    v_add_u32 v15, s64, v14
    v_add_u32 v17, s64, v16
    s_cmp_lg_u32 s6, 1
    s_cbranch_scc1 Ldp_41b
    s_mov_b32 s68, 0
    s_branch Lfp_42e
Lfp_42:
    buffer_load_dword v11, v10, s[56:59], 0 offen sc1
Lfp_42e:
    s_waitcnt vmcnt(0)
    v_cmp_ne_u32 vcc, s3, v11
    s_add_u32 s68, s68, 1
    s_cmp_ge_u32 s68, 32768
    s_cbranch_scc1 Lfp_42x
    s_cbranch_vccnz Lfp_42
Lfp_42x:
Ldp_41b:
    s_barrier
    s_barrier
    ds_read_b128 v[36:39], v15 offset:0
    ds_read_b128 v[52:55], v17 offset:0
    ds_read_b128 v[56:59], v17 offset:1024
    ds_read_b128 v[40:43], v15 offset:1024
Lk_43:
    s_add_u32 s64, s64, 16384
    s_cmp_eq_u32 s64, 65536
    s_cselect_b32 s64, 0, s64
    s_add_u32 s60, s60, 1
    s_waitcnt lgkmcnt(0)
    v_mfma_f32_16x16x32_bf16 v[20:23], v[52:55], v[36:39], v[20:23]
    ds_read_b128 v[44:47], v15 offset:4096
    ds_read_b128 v[60:63], v17 offset:4096
    v_mfma_f32_16x16x32_bf16 v[24:27], v[56:59], v[36:39], v[24:27]
    ds_read_b128 v[64:67], v17 offset:5120
    ds_read_b128 v[48:51], v15 offset:5120
    v_add_u32 v15, s64, v14
    v_mfma_f32_16x16x32_bf16 v[28:31], v[52:55], v[40:43], v[28:31]
    v_add_u32 v17, s64, v16
    v_mfma_f32_16x16x32_bf16 v[32:35], v[56:59], v[40:43], v[32:35]
    s_cmp_lt_u32 s60, 18
    s_waitcnt lgkmcnt(0)
    s_barrier
    v_mfma_f32_16x16x32_bf16 v[20:23], v[60:63], v[44:47], v[20:23]
    ds_read_b128 v[36:39], v15 offset:0
    ds_read_b128 v[52:55], v17 offset:0
    v_mfma_f32_16x16x32_bf16 v[24:27], v[64:67], v[44:47], v[24:27]
    ds_read_b128 v[56:59], v17 offset:1024
    ds_read_b128 v[40:43], v15 offset:1024
    v_mfma_f32_16x16x32_bf16 v[28:31], v[60:63], v[48:51], v[28:31]
    v_mfma_f32_16x16x32_bf16 v[32:35], v[64:67], v[48:51], v[32:35]
    s_cbranch_scc1 Lk_43
    s_waitcnt lgkmcnt(0)
    s_nop 6
    v_max3_f32 v68, v20, v21, v22
    v_max3_f32 v72, v23, v24, v25
    v_max3_f32 v68, v68, v26, v27
    v_max_f32 v68, v68, v72
    v_max3_f32 v70, v28, v29, v30
    v_max3_f32 v73, v31, v32, v33
    v_max3_f32 v70, v70, v34, v35
    v_max_f32 v70, v70, v73
    v_mov_b32 v72, v68
    v_mov_b32 v73, v70
    s_nop 0
    v_permlane16_swap_b32 v68, v72
    v_permlane16_swap_b32 v70, v73
    s_nop 0
    v_max_f32 v68, v68, v72
    v_max_f32 v70, v70, v73
    v_mov_b32 v72, v68
    v_mov_b32 v73, v70
    s_nop 0
    v_permlane32_swap_b32 v68, v72
    v_permlane32_swap_b32 v70, v73
    s_nop 0
    v_max_f32 v68, v68, v72
    v_max_f32 v70, v70, v73
    s_mov_b32 s72, 0x3d2e1a93
    v_mul_f32 v68, s72, v68
    v_mul_f32 v70, s72, v70
    v_fma_f32 v20, v20, s72, -v68
    v_fma_f32 v21, v21, s72, -v68
    v_fma_f32 v22, v22, s72, -v68
    v_fma_f32 v23, v23, s72, -v68
    v_fma_f32 v24, v24, s72, -v68
    v_fma_f32 v25, v25, s72, -v68
    v_fma_f32 v26, v26, s72, -v68
    v_fma_f32 v27, v27, s72, -v68
    v_fma_f32 v28, v28, s72, -v70
    v_fma_f32 v29, v29, s72, -v70
    v_fma_f32 v30, v30, s72, -v70
    v_fma_f32 v31, v31, s72, -v70
    v_fma_f32 v32, v32, s72, -v70
    v_fma_f32 v33, v33, s72, -v70
    v_fma_f32 v34, v34, s72, -v70
    v_fma_f32 v35, v35, s72, -v70
    s_lshl_b32 s12, s14, 3
    s_lshl_b32 s13, s8, 1
    s_add_u32 s12, s12, s13
    s_add_u32 s12, s12, s70
    s_lshl_b32 s13, s9, 1
    s_add_u32 s13, s13, s71
    s_mul_i32 s73, s12, 18432
    s_add_u32 s74, s73, 8192
    s_lshl_b32 s75, s13, 10
    s_add_u32 s73, s73, s75
    s_lshl_b32 s75, s13, 7
    s_add_u32 s74, s74, s75
    s_add_u32 s75, s73, 9216
    s_add_u32 s72, s74, 9216
    v_exp_f32 v20, v20
    v_exp_f32 v21, v21
    v_exp_f32 v22, v22
    v_exp_f32 v23, v23
    v_exp_f32 v24, v24
    v_exp_f32 v25, v25
    v_exp_f32 v26, v26
    v_exp_f32 v27, v27
    s_nop 0
    v_add_f32 v69, v20, v21
    v_add_f32 v72, v22, v23
    v_add_f32 v69, v69, v24
    v_add_f32 v72, v72, v25
    v_add_f32 v69, v69, v26
    v_add_f32 v72, v72, v27
    v_add_f32 v69, v69, v72
    v_cvt_pk_bf16_f32 v20, v20, v21
    v_cvt_pk_bf16_f32 v21, v22, v23
    v_cvt_pk_bf16_f32 v22, v24, v25
    v_cvt_pk_bf16_f32 v23, v26, v27
    buffer_store_dwordx4 v[20:23], v5, s[48:51], s73 offen sc1
    v_exp_f32 v28, v28
    v_exp_f32 v29, v29
    v_exp_f32 v30, v30
    v_exp_f32 v31, v31
    v_exp_f32 v32, v32
    v_exp_f32 v33, v33
    v_exp_f32 v34, v34
    v_exp_f32 v35, v35
    s_nop 0
    v_add_f32 v71, v28, v29
    v_add_f32 v73, v30, v31
    v_add_f32 v71, v71, v32
    v_add_f32 v73, v73, v33
    v_add_f32 v71, v71, v34
    v_add_f32 v73, v73, v35
    v_add_f32 v71, v71, v73
    v_cvt_pk_bf16_f32 v28, v28, v29
    v_cvt_pk_bf16_f32 v29, v30, v31
    v_cvt_pk_bf16_f32 v30, v32, v33
    v_cvt_pk_bf16_f32 v31, v34, v35
    buffer_store_dwordx4 v[28:31], v5, s[48:51], s75 offen sc1
    v_mov_b32 v72, v69
    v_mov_b32 v73, v71
    s_nop 0
    v_permlane16_swap_b32 v69, v72
    v_permlane16_swap_b32 v71, v73
    s_nop 0
    v_add_f32 v69, v69, v72
    v_add_f32 v71, v71, v73
    v_mov_b32 v72, v69
    v_mov_b32 v73, v71
    s_nop 0
    v_permlane32_swap_b32 v69, v72
    v_permlane32_swap_b32 v71, v73
    s_nop 0
    v_add_f32 v69, v69, v72
    v_add_f32 v71, v71, v73
    v_lshlrev_b32 v74, 3, v2
    s_mov_b64 exec, 0xffff
    buffer_store_dwordx2 v[68:69], v74, s[48:51], s74 offen sc1
    buffer_store_dwordx2 v[70:71], v74, s[48:51], s72 offen sc1
    s_mov_b64 exec, -1
    s_branch ph3_fin
k3_ab:
    s_mul_i32 s9, s15, 9
    s_add_u32 s9, s9, s5
    s_mov_b32 s8, s14
    s_add_u32 s94, s101, 512
    s_cmp_ge_u32 s9, 18
    s_cbranch_scc1 k3_bvt
    s_add_u32 s40, s38, 4718592
    s_addc_u32 s41, s39, 0
    s_mov_b32 s42, 737280
    s_mov_b32 s43, 0x20000
    s_mov_b32 s44, s26
    s_mov_b32 s45, s27
    s_mov_b32 s46, 2654208
    s_mov_b32 s47, 0x20000
    s_add_u32 s48, s38, 5505024
    s_addc_u32 s49, s39, 0
    s_mov_b32 s50, 368640
    s_mov_b32 s51, 0x20000
    s_mul_i32 s10, s8, 2560
    s_mul_i32 s11, s9, 147456
    s_mul_i32 s12, s8, 184320
    s_mul_i32 s13, s9, 10240
    s_add_u32 s12, s12, s13
    s_cmp_lt_u32 s6, 4
    s_cbranch_scc1 Lcomp_44
    s_sub_u32 s74, s6, 4
    s_mul_i32 s68, s74, 8
    v_lshrrev_b32 v6, 3, v1
    v_add_u32 v6, s68, v6
    v_and_b32 v7, 7, v1
    v_add_u32 v8, 0, v6
    v_bfe_u32 v9, v8, 1, 3
    v_xor_b32 v9, v9, v7
    s_movk_i32 s68, 2304
    v_mul_u32_u24 v8, s68, v8
    v_lshl_add_u32 v10, v9, 4, v8
    v_add_u32 v10, s11, v10
    v_add_u32 v11, 73728, v10
    s_mul_i32 s68, s74, 5120
    s_add_u32 s68, s68, s10
    v_lshl_add_u32 v12, v1, 4, s68
    s_mul_i32 s65, s74, 2560
    s_mul_i32 s66, s74, 1024
    s_add_u32 s66, s66, 10240
    s_mov_b32 s61, 0
    s_mov_b32 s62, 0
    s_add_u32 s67, s65, 110592
    s_mov_b32 s60, 0
Lpr_47:
    s_mov_b32 m0, s66
    s_nop 0
    buffer_load_dwordx4 v10, s[44:47], s62 offen lds
    s_add_u32 m0, s66, 4096
    s_nop 0
    buffer_load_dwordx4 v11, s[44:47], s62 offen lds
    s_add_u32 s62, s62, 128
    s_add_u32 s66, s66, 18432
    s_add_u32 s60, s60, 1
    s_cmp_lt_u32 s60, 5
    s_cbranch_scc1 Lpr_47
    s_barrier
    s_mov_b32 s60, 0
Lpr_48:
    s_mov_b32 m0, s65
    s_nop 0
    buffer_load_dwordx4 v12, s[40:43], s61 offen lds
    buffer_load_dwordx4 v12, s[40:43], s61 offen offset:1024 lds
    s_mov_b32 exec_hi, 0
    buffer_load_dwordx4 v12, s[40:43], s61 offen offset:2048 lds
    s_mov_b32 exec_hi, -1
    s_add_u32 s61, s61, 20480
    s_add_u32 s65, s65, 18432
    s_add_u32 s60, s60, 1
    s_cmp_lt_u32 s60, 5
    s_cbranch_scc1 Lpr_48
Lld_45:
    s_cmp_ge_u32 s60, 9
    s_cbranch_scc1 Llsk_46s
    s_cmp_lg_u32 s60, 5
    s_cbranch_scc1 Llsk_460
    s_waitcnt vmcnt(12)
    s_branch Llsk_46
Llsk_460:
    s_cmp_lg_u32 s60, 6
    s_cbranch_scc1 Llsk_461
    s_waitcnt vmcnt(14)
    s_branch Llsk_46
Llsk_461:
    s_cmp_lg_u32 s60, 7
    s_cbranch_scc1 Llsk_462
    s_waitcnt vmcnt(16)
    s_branch Llsk_46
Llsk_462:
    s_waitcnt vmcnt(18)
    s_branch Llsk_46
Llsk_463:
Llsk_46s:
    s_waitcnt vmcnt(20)
Llsk_46:
    s_barrier
    s_mov_b32 m0, s66
    s_nop 0
    buffer_load_dwordx4 v10, s[44:47], s62 offen lds
    s_add_u32 m0, s66, 4096
    s_nop 0
    buffer_load_dwordx4 v11, s[44:47], s62 offen lds
    s_mov_b32 m0, s65
    s_nop 0
    buffer_load_dwordx4 v12, s[40:43], s61 offen lds
    buffer_load_dwordx4 v12, s[40:43], s61 offen offset:1024 lds
    s_mov_b32 exec_hi, 0
    buffer_load_dwordx4 v12, s[40:43], s61 offen offset:2048 lds
    s_mov_b32 exec_hi, -1
    s_add_u32 s61, s61, 20480
    s_add_u32 s65, s65, 18432
    s_add_u32 s62, s62, 128
    s_add_u32 s66, s66, 18432
    s_cmp_eq_u32 s65, s67
    s_cselect_b32 s68, 110592, 0
    s_sub_u32 s65, s65, s68
    s_sub_u32 s66, s66, s68
    s_add_u32 s60, s60, 1
    s_cmp_lt_u32 s60, 18
    s_cbranch_scc1 Lld_45
    s_waitcnt vmcnt(20)
    s_barrier
    s_waitcnt vmcnt(15)
    s_barrier
    s_waitcnt vmcnt(10)
    s_barrier
    s_waitcnt vmcnt(5)
    s_barrier
    s_waitcnt vmcnt(0)
    s_barrier
    s_barrier
    s_branch ph3_now
Lcomp_44:
    v_min_u32 v10, 33, v1
    v_lshlrev_b32 v10, 2, v10
    s_cmp_lg_u32 s6, 1
    s_cbranch_scc1 Ldp_49
    buffer_load_dword v11, v10, s[56:59], s94 offen sc1
Ldp_49:
    s_mov_b32 s70, 0
    s_and_b32 s71, s6, 3
    v_lshrrev_b32 v6, 1, v3
    v_mul_u32_u24 v6, 2560, v6
    v_lshl_add_u32 v6, v2, 5, v6
    v_and_b32 v7, 1, v3
    v_lshl_add_u32 v6, v7, 4, v6
    s_mul_i32 s72, s70, 2560
    s_add_u32 s72, s72, 0
    v_add_u32 v14, s72, v6
    v_bfe_u32 v6, v2, 1, 3
    v_xor_b32 v6, v6, v3
    v_lshlrev_b32 v6, 4, v6
    v_lshl_add_u32 v6, v2, 7, v6
    s_mul_i32 s72, s71, 2048
    s_add_u32 s72, s72, 10240
    v_add_u32 v16, s72, v6
    v_xor_b32 v17, 64, v16
    v_mov_b32 v20, 0
    v_mov_b32 v21, 0
    v_mov_b32 v22, 0
    v_mov_b32 v23, 0
    v_mov_b32 v24, 0
    v_mov_b32 v25, 0
    v_mov_b32 v26, 0
    v_mov_b32 v27, 0
    v_mov_b32 v28, 0
    v_mov_b32 v29, 0
    v_mov_b32 v30, 0
    v_mov_b32 v31, 0
    v_mov_b32 v32, 0
    v_mov_b32 v33, 0
    v_mov_b32 v34, 0
    v_mov_b32 v35, 0
    v_mov_b32 v36, 0
    v_mov_b32 v37, 0
    v_mov_b32 v38, 0
    v_mov_b32 v39, 0
    s_mov_b32 s60, 0
    s_mov_b32 s64, 0
    v_add_u32 v15, s64, v14
    v_add_u32 v18, s64, v16
    v_add_u32 v19, s64, v17
    s_cmp_lg_u32 s6, 1
    s_cbranch_scc1 Ldp_49b
    s_mov_b32 s68, 0
    s_branch Lfp_50e
Lfp_50:
    buffer_load_dword v11, v10, s[56:59], s94 offen sc1
Lfp_50e:
    s_waitcnt vmcnt(0)
    v_cmp_ne_u32 vcc, s3, v11
    s_add_u32 s68, s68, 1
    s_cmp_ge_u32 s68, 32768
    s_cbranch_scc1 Lfp_50x
    s_cbranch_vccnz Lfp_50
Lfp_50x:
Ldp_49b:
    s_barrier
    s_barrier
    ds_read_b128 v[40:43], v15 offset:0
    ds_read_b128 v[80:83], v18 offset:0
    ds_read_b128 v[44:47], v15 offset:512
    ds_read_b128 v[48:51], v15 offset:1024
    ds_read_b128 v[52:55], v15 offset:1536
    ds_read_b128 v[56:59], v15 offset:2048
Lk_51:
    s_add_u32 s64, s64, 18432
    s_cmp_eq_u32 s64, 110592
    s_cselect_b32 s64, 0, s64
    s_add_u32 s60, s60, 1
    s_waitcnt lgkmcnt(0)
    v_mfma_f32_16x16x32_bf16 v[20:23], v[80:83], v[40:43], v[20:23]
    ds_read_b128 v[60:63], v15 offset:5120
    ds_read_b128 v[84:87], v19 offset:0
    v_mfma_f32_16x16x32_bf16 v[24:27], v[80:83], v[44:47], v[24:27]
    ds_read_b128 v[64:67], v15 offset:5632
    ds_read_b128 v[68:71], v15 offset:6144
    v_mfma_f32_16x16x32_bf16 v[28:31], v[80:83], v[48:51], v[28:31]
    ds_read_b128 v[72:75], v15 offset:6656
    ds_read_b128 v[76:79], v15 offset:7168
    v_add_u32 v15, s64, v14
    v_mfma_f32_16x16x32_bf16 v[32:35], v[80:83], v[52:55], v[32:35]
    v_add_u32 v18, s64, v16
    v_mfma_f32_16x16x32_bf16 v[36:39], v[80:83], v[56:59], v[36:39]
    v_add_u32 v19, s64, v17
    s_cmp_lt_u32 s60, 18
    s_waitcnt lgkmcnt(0)
    s_barrier
    v_mfma_f32_16x16x32_bf16 v[20:23], v[84:87], v[60:63], v[20:23]
    ds_read_b128 v[40:43], v15 offset:0
    ds_read_b128 v[80:83], v18 offset:0
    v_mfma_f32_16x16x32_bf16 v[24:27], v[84:87], v[64:67], v[24:27]
    ds_read_b128 v[44:47], v15 offset:512
    ds_read_b128 v[48:51], v15 offset:1024
    v_mfma_f32_16x16x32_bf16 v[28:31], v[84:87], v[68:71], v[28:31]
    ds_read_b128 v[52:55], v15 offset:1536
    ds_read_b128 v[56:59], v15 offset:2048
    v_mfma_f32_16x16x32_bf16 v[32:35], v[84:87], v[72:75], v[32:35]
    v_mfma_f32_16x16x32_bf16 v[36:39], v[84:87], v[76:79], v[36:39]
    s_cbranch_scc1 Lk_51
    s_waitcnt lgkmcnt(0)
    s_nop 6
    s_mul_i32 s72, s71, 2560
    s_add_u32 s72, s72, s12
    v_cvt_pk_bf16_f32 v20, v20, v21
    v_cvt_pk_bf16_f32 v21, v22, v23
    v_cvt_pk_bf16_f32 v22, v24, v25
    v_cvt_pk_bf16_f32 v23, v26, v27
    buffer_store_dwordx4 v[20:23], v5, s[48:51], s72 offen offset:0 sc1
    v_cvt_pk_bf16_f32 v28, v28, v29
    v_cvt_pk_bf16_f32 v29, v30, v31
    v_cvt_pk_bf16_f32 v30, v32, v33
    v_cvt_pk_bf16_f32 v31, v34, v35
    buffer_store_dwordx4 v[28:31], v5, s[48:51], s72 offen offset:1024 sc1
    v_cvt_pk_bf16_f32 v36, v36, v37
    v_cvt_pk_bf16_f32 v37, v38, v39
    v_lshlrev_b32 v38, 3, v1
    buffer_store_dwordx2 v[36:37], v38, s[48:51], s72 offen offset:2048 sc1
    s_branch ph3_fin
k3_bvt:
    s_sub_u32 s9, s9, 18
    s_add_u32 s94, s94, 136
    s_add_u32 s40, s38, 4718592
    s_addc_u32 s41, s39, 0
    s_mov_b32 s42, 737280
    s_mov_b32 s43, 0x20000
    s_mov_b32 s44, s30
    s_mov_b32 s45, s31
    s_mov_b32 s46, 2654208
    s_mov_b32 s47, 0x20000
    s_add_u32 s48, s38, 5898240
    s_addc_u32 s49, s39, 0
    s_mov_b32 s50, 368640
    s_mov_b32 s51, 0x20000
    s_mul_i32 s10, s8, 2560
    s_add_u32 s10, s10, 368640
    s_lshl_b32 s11, s9, 7
    s_mul_i32 s12, s8, 184320
    s_mul_i32 s13, s9, 10240
    s_add_u32 s12, s12, s13
    s_cmp_lt_u32 s6, 4
    s_cbranch_scc1 Lcomp_52
    s_sub_u32 s74, s6, 4
    s_lshl_b32 s68, s74, 3
    v_lshrrev_b32 v6, 3, v1
    v_add_u32 v6, s68, v6
    v_and_b32 v7, 7, v1
    v_and_b32 v8, 2, v6
    v_bfe_u32 v9, v6, 3, 1
    v_lshl_or_b32 v8, v9, 2, v8
    v_xor_b32 v7, v7, v8
    s_movk_i32 s68, 2304
    v_mul_u32_u24 v6, s68, v6
    v_lshl_add_u32 v10, v7, 4, v6
    v_add_u32 v10, s11, v10
    v_add_u32 v11, 73728, v10
    s_mul_i32 s68, s74, 5120
    s_add_u32 s68, s68, s10
    v_lshl_add_u32 v12, v1, 4, s68
    s_mul_i32 s65, s74, 2560
    s_mul_i32 s66, s74, 1024
    s_add_u32 s66, s66, 10240
    s_mov_b32 s61, 0
    s_mov_b32 s62, 0
    s_add_u32 s67, s65, 110592
    s_mov_b32 s60, 0
Lpr_55:
    s_mov_b32 m0, s66
    s_nop 0
    buffer_load_dwordx4 v10, s[44:47], s62 offen lds
    s_add_u32 m0, s66, 4096
    s_nop 0
    buffer_load_dwordx4 v11, s[44:47], s62 offen lds
    s_add_u32 s62, s62, 147456
    s_add_u32 s66, s66, 18432
    s_add_u32 s60, s60, 1
    s_cmp_lt_u32 s60, 5
    s_cbranch_scc1 Lpr_55
    s_barrier
    s_mov_b32 s60, 0
Lpr_56:
    s_mov_b32 m0, s65
    s_nop 0
    buffer_load_dwordx4 v12, s[40:43], s61 offen lds
    buffer_load_dwordx4 v12, s[40:43], s61 offen offset:1024 lds
    s_mov_b32 exec_hi, 0
    buffer_load_dwordx4 v12, s[40:43], s61 offen offset:2048 lds
    s_mov_b32 exec_hi, -1
    s_add_u32 s61, s61, 20480
    s_add_u32 s65, s65, 18432
    s_add_u32 s60, s60, 1
    s_cmp_lt_u32 s60, 5
    s_cbranch_scc1 Lpr_56
Lld_53:
    s_cmp_ge_u32 s60, 9
    s_cbranch_scc1 Llsk_54s
    s_cmp_lg_u32 s60, 5
    s_cbranch_scc1 Llsk_540
    s_waitcnt vmcnt(12)
    s_branch Llsk_54
Llsk_540:
    s_cmp_lg_u32 s60, 6
    s_cbranch_scc1 Llsk_541
    s_waitcnt vmcnt(14)
    s_branch Llsk_54
Llsk_541:
    s_cmp_lg_u32 s60, 7
    s_cbranch_scc1 Llsk_542
    s_waitcnt vmcnt(16)
    s_branch Llsk_54
Llsk_542:
    s_waitcnt vmcnt(18)
    s_branch Llsk_54
Llsk_543:
Llsk_54s:
    s_waitcnt vmcnt(20)
Llsk_54:
    s_barrier
    s_mov_b32 m0, s66
    s_nop 0
    buffer_load_dwordx4 v10, s[44:47], s62 offen lds
    s_add_u32 m0, s66, 4096
    s_nop 0
    buffer_load_dwordx4 v11, s[44:47], s62 offen lds
    s_mov_b32 m0, s65
    s_nop 0
    buffer_load_dwordx4 v12, s[40:43], s61 offen lds
    buffer_load_dwordx4 v12, s[40:43], s61 offen offset:1024 lds
    s_mov_b32 exec_hi, 0
    buffer_load_dwordx4 v12, s[40:43], s61 offen offset:2048 lds
    s_mov_b32 exec_hi, -1
    s_add_u32 s61, s61, 20480
    s_add_u32 s65, s65, 18432
    s_add_u32 s62, s62, 147456
    s_add_u32 s66, s66, 18432
    s_cmp_eq_u32 s65, s67
    s_cselect_b32 s68, 110592, 0
    s_sub_u32 s65, s65, s68
    s_sub_u32 s66, s66, s68
    s_add_u32 s60, s60, 1
    s_cmp_lt_u32 s60, 18
    s_cbranch_scc1 Lld_53
    s_waitcnt vmcnt(20)
    s_barrier
    s_waitcnt vmcnt(15)
    s_barrier
    s_waitcnt vmcnt(10)
    s_barrier
    s_waitcnt vmcnt(5)
    s_barrier
    s_waitcnt vmcnt(0)
    s_barrier
    s_barrier
    s_branch ph3_now
Lcomp_52:
    v_min_u32 v10, 17, v1
    v_lshlrev_b32 v10, 2, v10
    s_cmp_lg_u32 s6, 1
    s_cbranch_scc1 Ldp_57
    buffer_load_dword v11, v10, s[56:59], s94 offen sc1
Ldp_57:
    s_mov_b32 s70, 0
    s_and_b32 s71, s6, 3
    v_lshrrev_b32 v6, 1, v3
    v_mul_u32_u24 v6, 2560, v6
    v_lshl_add_u32 v6, v2, 5, v6
    v_and_b32 v7, 1, v3
    v_lshl_add_u32 v6, v7, 4, v6
    s_mul_i32 s72, s70, 2560
    s_add_u32 s72, s72, 0
    v_add_u32 v14, s72, v6
    v_lshrrev_b32 v6, 2, v2
    v_lshl_add_u32 v7, v3, 3, v6
    v_lshlrev_b32 v7, 7, v7
    v_and_b32 v8, 1, v2
    v_lshl_add_u32 v7, v8, 3, v7
    v_add_u32 v7, 10240, v7
    v_and_b32 v8, 1, v3
    v_lshrrev_b32 v9, 3, v2
    v_lshl_or_b32 v8, v8, 1, v9
    v_lshlrev_b32 v8, 1, v8
    v_bfe_u32 v9, v2, 1, 1
    v_or_b32 v8, v8, v9
    s_mul_i32 s72, s71, 2
    s_add_u32 s72, s72, 0
    v_xor_b32 v9, s72, v8
    v_lshl_add_u32 v16, v9, 4, v7
    v_mov_b32 v20, 0
    v_mov_b32 v21, 0
    v_mov_b32 v22, 0
    v_mov_b32 v23, 0
    v_mov_b32 v24, 0
    v_mov_b32 v25, 0
    v_mov_b32 v26, 0
    v_mov_b32 v27, 0
    v_mov_b32 v28, 0
    v_mov_b32 v29, 0
    v_mov_b32 v30, 0
    v_mov_b32 v31, 0
    v_mov_b32 v32, 0
    v_mov_b32 v33, 0
    v_mov_b32 v34, 0
    v_mov_b32 v35, 0
    v_mov_b32 v36, 0
    v_mov_b32 v37, 0
    v_mov_b32 v38, 0
    v_mov_b32 v39, 0
    s_mov_b32 s60, 0
    s_mov_b32 s64, 0
    v_add_u32 v15, s64, v14
    v_add_u32 v17, s64, v16
    s_cmp_lg_u32 s6, 1
    s_cbranch_scc1 Ldp_57b
    s_mov_b32 s68, 0
    s_branch Lfp_58e
Lfp_58:
    buffer_load_dword v11, v10, s[56:59], s94 offen sc1
Lfp_58e:
    s_waitcnt vmcnt(0)
    v_cmp_ne_u32 vcc, s3, v11
    s_add_u32 s68, s68, 1
    s_cmp_ge_u32 s68, 32768
    s_cbranch_scc1 Lfp_58x
    s_cbranch_vccnz Lfp_58
Lfp_58x:
Ldp_57b:
    s_barrier
    s_barrier
    ds_read_b128 v[40:43], v15 offset:0
    ds_read_b64_tr_b16 v[80:81], v17 offset:0
    ds_read_b64_tr_b16 v[82:83], v17 offset:512
    ds_read_b128 v[44:47], v15 offset:512
    ds_read_b128 v[48:51], v15 offset:1024
    ds_read_b128 v[52:55], v15 offset:1536
    ds_read_b128 v[56:59], v15 offset:2048
Lk_59:
    s_add_u32 s64, s64, 18432
    s_cmp_eq_u32 s64, 110592
    s_cselect_b32 s64, 0, s64
    s_add_u32 s60, s60, 1
    s_waitcnt lgkmcnt(0)
    v_mfma_f32_16x16x32_bf16 v[20:23], v[40:43], v[80:83], v[20:23]
    ds_read_b128 v[60:63], v15 offset:5120
    ds_read_b64_tr_b16 v[84:85], v17 offset:4096
    v_mfma_f32_16x16x32_bf16 v[24:27], v[44:47], v[80:83], v[24:27]
    ds_read_b64_tr_b16 v[86:87], v17 offset:4608
    ds_read_b128 v[64:67], v15 offset:5632
    v_mfma_f32_16x16x32_bf16 v[28:31], v[48:51], v[80:83], v[28:31]
    ds_read_b128 v[68:71], v15 offset:6144
    ds_read_b128 v[72:75], v15 offset:6656
    v_mfma_f32_16x16x32_bf16 v[32:35], v[52:55], v[80:83], v[32:35]
    ds_read_b128 v[76:79], v15 offset:7168
    v_add_u32 v15, s64, v14
    v_mfma_f32_16x16x32_bf16 v[36:39], v[56:59], v[80:83], v[36:39]
    v_add_u32 v17, s64, v16
    s_cmp_lt_u32 s60, 18
    s_waitcnt lgkmcnt(0)
    s_barrier
    v_mfma_f32_16x16x32_bf16 v[20:23], v[60:63], v[84:87], v[20:23]
    ds_read_b128 v[40:43], v15 offset:0
    ds_read_b64_tr_b16 v[80:81], v17 offset:0
    v_mfma_f32_16x16x32_bf16 v[24:27], v[64:67], v[84:87], v[24:27]
    ds_read_b64_tr_b16 v[82:83], v17 offset:512
    ds_read_b128 v[44:47], v15 offset:512
    v_mfma_f32_16x16x32_bf16 v[28:31], v[68:71], v[84:87], v[28:31]
    ds_read_b128 v[48:51], v15 offset:1024
    ds_read_b128 v[52:55], v15 offset:1536
    v_mfma_f32_16x16x32_bf16 v[32:35], v[72:75], v[84:87], v[32:35]
    ds_read_b128 v[56:59], v15 offset:2048
    v_mfma_f32_16x16x32_bf16 v[36:39], v[76:79], v[84:87], v[36:39]
    s_cbranch_scc1 Lk_59
    s_waitcnt lgkmcnt(0)
    s_nop 6
    s_mul_i32 s72, s71, 2560
    s_add_u32 s72, s72, s12
    v_cvt_pk_bf16_f32 v20, v20, v21
    v_cvt_pk_bf16_f32 v21, v22, v23
    v_cvt_pk_bf16_f32 v22, v24, v25
    v_cvt_pk_bf16_f32 v23, v26, v27
    buffer_store_dwordx4 v[20:23], v5, s[48:51], s72 offen offset:0 sc1
    v_cvt_pk_bf16_f32 v28, v28, v29
    v_cvt_pk_bf16_f32 v29, v30, v31
    v_cvt_pk_bf16_f32 v30, v32, v33
    v_cvt_pk_bf16_f32 v31, v34, v35
    buffer_store_dwordx4 v[28:31], v5, s[48:51], s72 offen offset:1024 sc1
    v_cvt_pk_bf16_f32 v36, v36, v37
    v_cvt_pk_bf16_f32 v37, v38, v39
    v_lshlrev_b32 v38, 3, v1
    buffer_store_dwordx2 v[36:37], v38, s[48:51], s72 offen offset:2048 sc1
    s_branch ph3_fin
k3_misc:
    s_cmp_eq_u32 s15, 0
    s_cbranch_scc1 k3_gate
    s_add_u32 s48, s38, 7864320
    s_addc_u32 s49, s39, 0
    s_mov_b32 s50, 786432
    s_mov_b32 s51, 0x20000
    s_sub_u32 s7, s15, 1
    s_lshl_b32 s7, s7, 13
    s_mul_i32 s8, s14, 393216
    s_add_u32 s7, s7, s8
    s_add_u32 s8, s8, 393216
    v_lshlrev_b32 v7, 4, v0
    v_mov_b32 v8, -1
    v_mov_b32 v9, -1
    v_mov_b32 v10, -1
    v_mov_b32 v11, -1
Lfill_60:
    buffer_store_dwordx4 v[8:11], v7, s[48:51], s7 offen sc1
    s_add_u32 s7, s7, 24576
    s_cmp_lt_u32 s7, s8
    s_cbranch_scc1 Lfill_60
    s_branch ph3_fin
k3_gate:
    s_add_u32 s40, s38, 8912896
    s_addc_u32 s41, s39, 0
    s_mov_b32 s42, 444416
    s_mov_b32 s43, 0x20000
    s_add_u32 s48, s38, 7774208
    s_addc_u32 s49, s39, 0
    s_mov_b32 s50, 9216
    s_mov_b32 s51, 0x20000
    v_min_u32 v6, 287, v0
    v_lshlrev_b32 v6, 4, v6
    s_mul_i32 s9, s14, 13824
    s_add_u32 s9, s9, 9216
    s_add_u32 s10, s9, 27648
    s_mul_i32 s11, s14, 4608
    s_mov_b32 s68, 0x0c0c0400
    s_mov_b32 s69, 0x04000c0c
    s_mov_b32 s12, 0
Lgp_61:
    buffer_load_dwordx4 v[8:11], v6, s[40:43], s9 offen sc1
    buffer_load_dwordx4 v[12:15], v6, s[40:43], s10 offen sc1
    s_add_u32 s12, s12, 1
    s_waitcnt vmcnt(0)
    v_perm_b32 v16, v9, v8, s68
    v_perm_b32 v17, v11, v10, s69
    v_perm_b32 v18, v13, v12, s68
    v_perm_b32 v19, v15, v14, s69
    v_or_b32 v16, v16, v17
    v_or_b32 v18, v18, v19
    v_xor_b32 v16, s3, v16
    v_xor_b32 v18, s3, v18
    v_or_b32 v16, v16, v18
    v_cmp_ne_u32 vcc, 0, v16
    s_cmp_ge_u32 s12, 32768
    s_cbranch_scc1 Lgp_61x
    s_nop 0
    s_cbranch_vccnz Lgp_61
Lgp_61x:
    v_and_b32 v8, 0xffffff00, v8
    v_and_b32 v9, 0xffffff00, v9
    v_and_b32 v10, 0xffffff00, v10
    v_and_b32 v11, 0xffffff00, v11
    v_and_b32 v12, 0xffffff00, v12
    v_and_b32 v13, 0xffffff00, v13
    v_and_b32 v14, 0xffffff00, v14
    v_and_b32 v15, 0xffffff00, v15
    v_pk_add_f32 v[8:9], v[8:9], v[12:13]
    v_pk_add_f32 v[10:11], v[10:11], v[14:15]
    buffer_store_dwordx4 v[8:11], v6, s[48:51], s11 offen sc1
ph3_fin:
    s_waitcnt vmcnt(0) lgkmcnt(0)
ph3_now:
    s_barrier
    s_cmp_lg_u32 s6, 0
    s_cbranch_scc1 Lfw_62
    s_cmp_lt_i32 s93, 0
    s_cbranch_scc1 Lfw_62
    v_mov_b32 v6, s3
    v_mov_b32 v7, 2304
    v_mul_u32_u24 v7, v7, v1
    s_bfm_b64 exec, s100, 0
    s_cmp_eq_u32 s100, 64
    s_cselect_b64 exec, -1, exec
    buffer_store_dword v6, v7, s[56:59], s93 offen sc1
    s_mov_b64 exec, -1
Lfw_62:
    s_cmp_ge_u32 s6, 4
    s_cbranch_scc1 standalone__pixart__diffusion_kernel_end
    s_cmp_eq_u32 s6, 3
    s_cbranch_scc1 k4_poll
    s_lshr_b32 s7, s4, 2
    s_and_b32 s8, s4, 3
    s_lshl_b32 s8, s8, 1
    s_and_b32 s12, s5, 1
    s_add_u32 s8, s8, s12
    s_lshr_b32 s9, s5, 1
    s_lshl_b32 s11, s7, 4
    s_add_u32 s11, s11, s9
    s_mul_i32 s10, s8, 9
    s_mul_i32 s12, s6, 3
    s_add_u32 s10, s10, s12
    v_lshlrev_b32 v10, 3, v1
    v_lshlrev_b32 v11, 4, v3
    s_lshl_b32 s12, s11, 4
    v_add_u32 v9, s12, v2
    s_movk_i32 s12, 2304
    v_mul_u32_u24 v9, s12, v9
    v_lshl_add_u32 v9, v3, 3, v9
    s_lshl_b32 s12, s10, 5
    v_add_u32 v9, s12, v9
    s_mul_i32 s12, s7, 4608
    s_mul_i32 s13, s8, 576
    s_add_u32 s12, s12, s13
    s_mul_i32 s14, s11, 9216
    s_mul_i32 s15, s6, 3072
    v_add_u32 v6, s12, v5
    v_mov_b32 v7, 0x3f803f80
    v_cmp_eq_u32 vcc, 4, v2
    s_nop 0
    v_cndmask_b32 v248, 0, v7, vcc
    v_cndmask_b32 v249, 0, v7, vcc
    v_cmp_eq_u32 vcc, 5, v2
    s_nop 0
    v_cndmask_b32 v250, 0, v7, vcc
    v_cndmask_b32 v251, 0, v7, vcc
    v_cmp_eq_u32 vcc, 8, v2
    s_nop 0
    v_cndmask_b32 v252, 0, v7, vcc
    v_cndmask_b32 v253, 0, v7, vcc
    v_cmp_eq_u32 vcc, 9, v2
    s_nop 0
    v_cndmask_b32 v254, 0, v7, vcc
    v_cndmask_b32 v255, 0, v7, vcc
    v_cmp_eq_u32 vcc, 12, v2
    s_nop 0
    v_cndmask_b32 v222, 0, v7, vcc
    v_cndmask_b32 v223, 0, v7, vcc
    s_add_u32 s14, s14, s15
    s_add_u32 s15, s15, 24576
    s_mul_i32 s60, s7, 589824
    s_lshl_b32 s61, s10, 10
    s_add_u32 s60, s60, s61
    s_mul_i32 s61, s7, 184320
    s_mul_i32 s62, s10, 2560
    s_add_u32 s61, s61, s62
    s_mov_b32 s40, s16
    s_mov_b32 s41, s17
    s_mov_b32 s42, 1179648
    s_mov_b32 s43, 0x20000
    buffer_load_dwordx2 v[168:169], v9, s[40:43], 0 offen offset:0
    buffer_load_dwordx2 v[170:171], v9, s[40:43], 0 offen offset:32
    buffer_load_dwordx2 v[172:173], v9, s[40:43], 0 offen offset:64
    s_add_u32 s44, s38, 7471104
    s_addc_u32 s45, s39, 0
    s_mov_b32 s46, 294912
    s_mov_b32 s47, 0x20000
    s_add_u32 s52, s38, 6291456
    s_addc_u32 s53, s39, 0
    s_mov_b32 s54, 1179648
    s_mov_b32 s55, 0x20000
    s_mul_i32 s12, s6, 7680
    s_add_u32 s12, s12, 36864
    v_add_u32 v246, s12, v5
    v_add_u32 v247, s12, v10
    s_mov_b32 m0, s15
    s_add_u32 s40, s38, 7774208
    s_addc_u32 s41, s39, 0
    s_mov_b32 s42, 9216
    s_barrier
    buffer_load_dwordx4 v5, s[44:47], s14 offen offset:0 lds
    buffer_load_dwordx4 v5, s[44:47], s14 offen offset:1024 lds
    buffer_load_dwordx4 v5, s[44:47], s14 offen offset:2048 lds
    s_mov_b32 m0, 33792
    s_cmp_lg_u32 s6, 0
    s_cbranch_scc1 Lgc_63
    buffer_load_dwordx4 v6, s[40:43], 0 offen lds
Lgc_63:
    buffer_load_dwordx4 v[24:27], v5, s[52:55], s60 offen offset:0
    buffer_load_dwordx4 v[28:31], v5, s[52:55], s60 offen offset:1024
    buffer_load_dwordx4 v[32:35], v5, s[52:55], s60 offen offset:2048
    s_add_u32 s60, s60, 73728
    buffer_load_dwordx4 v[36:39], v5, s[52:55], s60 offen offset:0
    buffer_load_dwordx4 v[40:43], v5, s[52:55], s60 offen offset:1024
    buffer_load_dwordx4 v[44:47], v5, s[52:55], s60 offen offset:2048
    s_add_u32 s60, s60, 73728
    buffer_load_dwordx4 v[48:51], v5, s[52:55], s60 offen offset:0
    buffer_load_dwordx4 v[52:55], v5, s[52:55], s60 offen offset:1024
    buffer_load_dwordx4 v[56:59], v5, s[52:55], s60 offen offset:2048
    s_add_u32 s60, s60, 73728
    buffer_load_dwordx4 v[60:63], v5, s[52:55], s60 offen offset:0
    buffer_load_dwordx4 v[64:67], v5, s[52:55], s60 offen offset:1024
    buffer_load_dwordx4 v[68:71], v5, s[52:55], s60 offen offset:2048
    s_add_u32 s60, s60, 73728
    buffer_load_dwordx4 v[72:75], v5, s[52:55], s60 offen offset:0
    buffer_load_dwordx4 v[76:79], v5, s[52:55], s60 offen offset:1024
    buffer_load_dwordx4 v[80:83], v5, s[52:55], s60 offen offset:2048
    s_add_u32 s60, s60, 73728
    buffer_load_dwordx4 v[84:87], v5, s[52:55], s60 offen offset:0
    buffer_load_dwordx4 v[88:91], v5, s[52:55], s60 offen offset:1024
    buffer_load_dwordx4 v[92:95], v5, s[52:55], s60 offen offset:2048
    s_add_u32 s60, s60, 73728
    buffer_load_dwordx4 v[96:99], v5, s[52:55], s60 offen offset:0
    buffer_load_dwordx4 v[100:103], v5, s[52:55], s60 offen offset:1024
    buffer_load_dwordx4 v[104:107], v5, s[52:55], s60 offen offset:2048
    s_add_u32 s60, s60, 73728
    buffer_load_dwordx4 v[108:111], v5, s[52:55], s60 offen offset:0
    buffer_load_dwordx4 v[112:115], v5, s[52:55], s60 offen offset:1024
    buffer_load_dwordx4 v[116:119], v5, s[52:55], s60 offen offset:2048
    v_lshlrev_b32 v8, 3, v2
    v_add_u32 v8, 32768, v8
    s_mul_i32 s12, s6, 192
    v_add_u32 v7, s12, v11
    s_waitcnt vmcnt(24)
    s_barrier
    ds_read2_b64 v[152:155], v8 offset0:0 offset1:16
    ds_read2_b64 v[156:159], v8 offset0:32 offset1:48
    ds_read2_b64 v[160:163], v8 offset0:64 offset1:80
    ds_read2_b64 v[164:167], v8 offset0:96 offset1:112
    ds_read_b128 v[120:123], v5 offset:24576
    ds_read_b128 v[124:127], v5 offset:25600
    ds_read_b128 v[128:131], v5 offset:26624
    ds_read_b128 v[132:135], v5 offset:27648
    ds_read_b128 v[136:139], v5 offset:28672
    ds_read_b128 v[140:143], v5 offset:29696
    ds_read_b128 v[144:147], v5 offset:30720
    ds_read_b128 v[148:151], v5 offset:31744
    ds_read_b128 v[176:179], v7 offset:33792
    ds_read_b128 v[180:183], v7 offset:33856
    ds_read_b128 v[184:187], v7 offset:33920
    s_waitcnt lgkmcnt(11)
    v_max3_f32 v6, v152, v154, v156
    v_max3_f32 v8, v158, v160, v162
    v_max3_f32 v6, v6, v164, v166
    v_max_f32 v6, v6, v8
    v_sub_f32 v152, v152, v6
    v_sub_f32 v154, v154, v6
    v_sub_f32 v156, v156, v6
    v_sub_f32 v158, v158, v6
    v_sub_f32 v160, v160, v6
    v_sub_f32 v162, v162, v6
    v_sub_f32 v164, v164, v6
    v_sub_f32 v166, v166, v6
    v_exp_f32 v152, v152
    v_exp_f32 v154, v154
    v_exp_f32 v156, v156
    v_exp_f32 v158, v158
    v_exp_f32 v160, v160
    v_exp_f32 v162, v162
    v_exp_f32 v164, v164
    v_exp_f32 v166, v166
    v_mul_f32 v6, v152, v153
    v_fmac_f32 v6, v154, v155
    v_fmac_f32 v6, v156, v157
    v_fmac_f32 v6, v158, v159
    v_fmac_f32 v6, v160, v161
    v_fmac_f32 v6, v162, v163
    v_fmac_f32 v6, v164, v165
    v_fmac_f32 v6, v166, v167
    v_rcp_f32 v6, v6
    s_waitcnt lgkmcnt(0)
    v_mul_f32 v176, v176, v6
    v_mul_f32 v177, v177, v6
    v_mul_f32 v178, v178, v6
    v_mul_f32 v179, v179, v6
    v_mul_f32 v180, v180, v6
    v_mul_f32 v181, v181, v6
    v_mul_f32 v182, v182, v6
    v_mul_f32 v183, v183, v6
    v_mul_f32 v184, v184, v6
    v_mul_f32 v185, v185, v6
    v_mul_f32 v186, v186, v6
    v_mul_f32 v187, v187, v6
    s_waitcnt vmcnt(21)
    v_mfma_f32_16x16x32_bf16 v[188:191], v[24:27], v[120:123], 0
    v_mfma_f32_16x16x32_bf16 v[192:195], v[28:31], v[120:123], 0
    v_mfma_f32_16x16x32_bf16 v[196:199], v[32:35], v[120:123], 0
    s_waitcnt vmcnt(18)
    v_mfma_f32_16x16x32_bf16 v[200:203], v[36:39], v[124:127], 0
    v_mfma_f32_16x16x32_bf16 v[204:207], v[40:43], v[124:127], 0
    v_mfma_f32_16x16x32_bf16 v[208:211], v[44:47], v[124:127], 0
    s_nop 4
    v_mul_f32 v12, v152, v188
    v_mul_f32 v13, v152, v189
    v_mul_f32 v14, v152, v190
    v_mul_f32 v15, v152, v191
    v_mul_f32 v16, v152, v192
    v_mul_f32 v17, v152, v193
    v_mul_f32 v18, v152, v194
    v_mul_f32 v19, v152, v195
    v_mul_f32 v20, v152, v196
    v_mul_f32 v21, v152, v197
    v_mul_f32 v22, v152, v198
    v_mul_f32 v23, v152, v199
    s_waitcnt vmcnt(15)
    v_mfma_f32_16x16x32_bf16 v[188:191], v[48:51], v[128:131], 0
    v_mfma_f32_16x16x32_bf16 v[192:195], v[52:55], v[128:131], 0
    v_mfma_f32_16x16x32_bf16 v[196:199], v[56:59], v[128:131], 0
    v_fmac_f32 v12, v154, v200
    v_fmac_f32 v13, v154, v201
    v_fmac_f32 v14, v154, v202
    v_fmac_f32 v15, v154, v203
    v_fmac_f32 v16, v154, v204
    v_fmac_f32 v17, v154, v205
    v_fmac_f32 v18, v154, v206
    v_fmac_f32 v19, v154, v207
    v_fmac_f32 v20, v154, v208
    v_fmac_f32 v21, v154, v209
    v_fmac_f32 v22, v154, v210
    v_fmac_f32 v23, v154, v211
    s_waitcnt vmcnt(12)
    v_mfma_f32_16x16x32_bf16 v[200:203], v[60:63], v[132:135], 0
    v_mfma_f32_16x16x32_bf16 v[204:207], v[64:67], v[132:135], 0
    v_mfma_f32_16x16x32_bf16 v[208:211], v[68:71], v[132:135], 0
    v_fmac_f32 v12, v156, v188
    v_fmac_f32 v13, v156, v189
    v_fmac_f32 v14, v156, v190
    v_fmac_f32 v15, v156, v191
    v_fmac_f32 v16, v156, v192
    v_fmac_f32 v17, v156, v193
    v_fmac_f32 v18, v156, v194
    v_fmac_f32 v19, v156, v195
    v_fmac_f32 v20, v156, v196
    v_fmac_f32 v21, v156, v197
    v_fmac_f32 v22, v156, v198
    v_fmac_f32 v23, v156, v199
    s_waitcnt vmcnt(9)
    v_mfma_f32_16x16x32_bf16 v[188:191], v[72:75], v[136:139], 0
    v_mfma_f32_16x16x32_bf16 v[192:195], v[76:79], v[136:139], 0
    v_mfma_f32_16x16x32_bf16 v[196:199], v[80:83], v[136:139], 0
    v_fmac_f32 v12, v158, v200
    v_fmac_f32 v13, v158, v201
    v_fmac_f32 v14, v158, v202
    v_fmac_f32 v15, v158, v203
    v_fmac_f32 v16, v158, v204
    v_fmac_f32 v17, v158, v205
    v_fmac_f32 v18, v158, v206
    v_fmac_f32 v19, v158, v207
    v_fmac_f32 v20, v158, v208
    v_fmac_f32 v21, v158, v209
    v_fmac_f32 v22, v158, v210
    v_fmac_f32 v23, v158, v211
    s_waitcnt vmcnt(6)
    v_mfma_f32_16x16x32_bf16 v[200:203], v[84:87], v[140:143], 0
    v_mfma_f32_16x16x32_bf16 v[204:207], v[88:91], v[140:143], 0
    v_mfma_f32_16x16x32_bf16 v[208:211], v[92:95], v[140:143], 0
    v_fmac_f32 v12, v160, v188
    v_fmac_f32 v13, v160, v189
    v_fmac_f32 v14, v160, v190
    v_fmac_f32 v15, v160, v191
    v_fmac_f32 v16, v160, v192
    v_fmac_f32 v17, v160, v193
    v_fmac_f32 v18, v160, v194
    v_fmac_f32 v19, v160, v195
    v_fmac_f32 v20, v160, v196
    v_fmac_f32 v21, v160, v197
    v_fmac_f32 v22, v160, v198
    v_fmac_f32 v23, v160, v199
    s_waitcnt vmcnt(3)
    v_mfma_f32_16x16x32_bf16 v[188:191], v[96:99], v[144:147], 0
    v_mfma_f32_16x16x32_bf16 v[192:195], v[100:103], v[144:147], 0
    v_mfma_f32_16x16x32_bf16 v[196:199], v[104:107], v[144:147], 0
    v_fmac_f32 v12, v162, v200
    v_fmac_f32 v13, v162, v201
    v_fmac_f32 v14, v162, v202
    v_fmac_f32 v15, v162, v203
    v_fmac_f32 v16, v162, v204
    v_fmac_f32 v17, v162, v205
    v_fmac_f32 v18, v162, v206
    v_fmac_f32 v19, v162, v207
    v_fmac_f32 v20, v162, v208
    v_fmac_f32 v21, v162, v209
    v_fmac_f32 v22, v162, v210
    v_fmac_f32 v23, v162, v211
    s_waitcnt vmcnt(0)
    v_mfma_f32_16x16x32_bf16 v[200:203], v[108:111], v[148:151], 0
    v_mfma_f32_16x16x32_bf16 v[204:207], v[112:115], v[148:151], 0
    v_mfma_f32_16x16x32_bf16 v[208:211], v[116:119], v[148:151], 0
    v_fmac_f32 v12, v164, v188
    v_fmac_f32 v13, v164, v189
    v_fmac_f32 v14, v164, v190
    v_fmac_f32 v15, v164, v191
    v_fmac_f32 v16, v164, v192
    v_fmac_f32 v17, v164, v193
    v_fmac_f32 v18, v164, v194
    v_fmac_f32 v19, v164, v195
    v_fmac_f32 v20, v164, v196
    v_fmac_f32 v21, v164, v197
    v_fmac_f32 v22, v164, v198
    v_fmac_f32 v23, v164, v199
    s_nop 4
    v_fmac_f32 v12, v166, v200
    v_fmac_f32 v13, v166, v201
    v_fmac_f32 v14, v166, v202
    v_fmac_f32 v15, v166, v203
    v_fmac_f32 v16, v166, v204
    v_fmac_f32 v17, v166, v205
    v_fmac_f32 v18, v166, v206
    v_fmac_f32 v19, v166, v207
    v_fmac_f32 v20, v166, v208
    v_fmac_f32 v21, v166, v209
    v_fmac_f32 v22, v166, v210
    v_fmac_f32 v23, v166, v211
    v_lshlrev_b32 v128, 16, v168
    v_and_b32 v129, 0xffff0000, v168
    v_lshlrev_b32 v130, 16, v169
    v_and_b32 v131, 0xffff0000, v169
    v_lshlrev_b32 v132, 16, v170
    v_and_b32 v133, 0xffff0000, v170
    v_lshlrev_b32 v134, 16, v171
    v_and_b32 v135, 0xffff0000, v171
    v_lshlrev_b32 v136, 16, v172
    v_and_b32 v137, 0xffff0000, v172
    v_lshlrev_b32 v138, 16, v173
    v_and_b32 v139, 0xffff0000, v173
    s_barrier
    ds_read_b128 v[212:215], v246 offset:0
    ds_read_b128 v[216:219], v246 offset:1024
    ds_read_b64 v[220:221], v247 offset:2048
    ds_read_b128 v[224:227], v246 offset:2560
    ds_read_b128 v[228:231], v246 offset:3584
    ds_read_b64 v[232:233], v247 offset:4608
    ds_read_b128 v[236:239], v246 offset:5120
    ds_read_b128 v[240:243], v246 offset:6144
    ds_read_b64 v[244:245], v247 offset:7168
    v_fmac_f32 v128, v176, v12
    v_fmac_f32 v129, v177, v13
    v_fmac_f32 v130, v178, v14
    v_fmac_f32 v131, v179, v15
    v_fmac_f32 v132, v180, v16
    v_fmac_f32 v133, v181, v17
    v_fmac_f32 v134, v182, v18
    v_fmac_f32 v135, v183, v19
    v_fmac_f32 v136, v184, v20
    v_fmac_f32 v137, v185, v21
    v_fmac_f32 v138, v186, v22
    v_fmac_f32 v139, v187, v23
    v_cvt_pk_bf16_f32 v120, v128, v129
    v_cvt_pk_bf16_f32 v121, v130, v131
    v_cvt_pk_bf16_f32 v122, v132, v133
    v_cvt_pk_bf16_f32 v123, v134, v135
    v_cvt_pk_bf16_f32 v124, v136, v137
    v_cvt_pk_bf16_f32 v125, v138, v139
    s_mul_i32 s12, s6, 6144
    v_add_u32 v6, s12, v5
    s_waitcnt lgkmcnt(0)
    v_mfma_f32_16x16x16_bf16 v[188:191], v[212:213], v[120:121], 0
    v_lshlrev_b32 v12, 16, v120
    v_mfma_f32_16x16x16_bf16 v[208:211], v[248:249], v[212:213], 0
    v_and_b32 v13, 0xffff0000, v120
    v_lshlrev_b32 v14, 16, v121
    v_mfma_f32_16x16x16_bf16 v[192:195], v[214:215], v[120:121], 0
    v_and_b32 v15, 0xffff0000, v121
    v_mfma_f32_16x16x16_bf16 v[208:211], v[250:251], v[214:215], v[208:211]
    v_lshlrev_b32 v16, 16, v122
    v_and_b32 v17, 0xffff0000, v122
    v_mfma_f32_16x16x16_bf16 v[196:199], v[216:217], v[120:121], 0
    v_lshlrev_b32 v18, 16, v123
    v_mfma_f32_16x16x16_bf16 v[208:211], v[252:253], v[216:217], v[208:211]
    v_and_b32 v19, 0xffff0000, v123
    v_lshlrev_b32 v20, 16, v124
    v_mfma_f32_16x16x16_bf16 v[200:203], v[218:219], v[120:121], 0
    v_and_b32 v21, 0xffff0000, v124
    v_mfma_f32_16x16x16_bf16 v[208:211], v[254:255], v[218:219], v[208:211]
    v_lshlrev_b32 v22, 16, v125
    v_and_b32 v23, 0xffff0000, v125
    v_mfma_f32_16x16x16_bf16 v[204:207], v[220:221], v[120:121], 0
    v_pk_add_f32 v[152:153], v[12:13], v[14:15]
    v_mfma_f32_16x16x16_bf16 v[208:211], v[222:223], v[220:221], v[208:211]
    v_pk_mul_f32 v[154:155], v[12:13], v[12:13]
    v_pk_fma_f32 v[154:155], v[14:15], v[14:15], v[154:155]
    v_mfma_f32_16x16x16_bf16 v[188:191], v[224:225], v[122:123], v[188:191]
    v_pk_add_f32 v[152:153], v[152:153], v[16:17]
    v_mfma_f32_16x16x16_bf16 v[208:211], v[248:249], v[224:225], v[208:211]
    v_pk_fma_f32 v[154:155], v[16:17], v[16:17], v[154:155]
    v_pk_add_f32 v[152:153], v[152:153], v[18:19]
    v_mfma_f32_16x16x16_bf16 v[192:195], v[226:227], v[122:123], v[192:195]
    v_pk_fma_f32 v[154:155], v[18:19], v[18:19], v[154:155]
    v_mfma_f32_16x16x16_bf16 v[208:211], v[250:251], v[226:227], v[208:211]
    v_pk_add_f32 v[152:153], v[152:153], v[20:21]
    v_pk_fma_f32 v[154:155], v[20:21], v[20:21], v[154:155]
    v_mfma_f32_16x16x16_bf16 v[196:199], v[228:229], v[122:123], v[196:199]
    v_pk_add_f32 v[152:153], v[152:153], v[22:23]
    v_mfma_f32_16x16x16_bf16 v[208:211], v[252:253], v[228:229], v[208:211]
    v_pk_fma_f32 v[154:155], v[22:23], v[22:23], v[154:155]
    v_add_f32 v152, v152, v153
    v_mfma_f32_16x16x16_bf16 v[200:203], v[230:231], v[122:123], v[200:203]
    v_add_f32 v153, v154, v155
    v_mfma_f32_16x16x16_bf16 v[208:211], v[254:255], v[230:231], v[208:211]
    v_mov_b32 v154, v152
    v_mov_b32 v155, v153
    s_nop 1
    v_mfma_f32_16x16x16_bf16 v[204:207], v[232:233], v[122:123], v[204:207]
    v_permlane16_swap_b32 v152, v154
    v_mfma_f32_16x16x16_bf16 v[208:211], v[222:223], v[232:233], v[208:211]
    v_permlane16_swap_b32 v153, v155
    s_nop 0
    v_pk_add_f32 v[152:153], v[152:153], v[154:155]
    v_mfma_f32_16x16x16_bf16 v[188:191], v[236:237], v[124:125], v[188:191]
    v_mov_b32 v154, v152
    v_mfma_f32_16x16x16_bf16 v[208:211], v[248:249], v[236:237], v[208:211]
    v_mov_b32 v155, v153
    s_nop 1
    v_permlane32_swap_b32 v152, v154
    v_mfma_f32_16x16x16_bf16 v[192:195], v[238:239], v[124:125], v[192:195]
    v_permlane32_swap_b32 v153, v155
    s_nop 0
    v_mfma_f32_16x16x16_bf16 v[208:211], v[250:251], v[238:239], v[208:211]
    v_pk_add_f32 v[152:153], v[152:153], v[154:155]
    v_mfma_f32_16x16x16_bf16 v[196:199], v[240:241], v[124:125], v[196:199]
    v_mfma_f32_16x16x16_bf16 v[208:211], v[252:253], v[240:241], v[208:211]
    v_mfma_f32_16x16x16_bf16 v[200:203], v[242:243], v[124:125], v[200:203]
    v_mfma_f32_16x16x16_bf16 v[208:211], v[254:255], v[242:243], v[208:211]
    v_mfma_f32_16x16x16_bf16 v[204:207], v[244:245], v[124:125], v[204:207]
    v_mfma_f32_16x16x16_bf16 v[208:211], v[222:223], v[244:245], v[208:211]
    s_add_u32 s40, s38, 7864320
    s_addc_u32 s41, s39, 0
    s_mov_b32 s42, 786432
    s_mov_b32 s43, 0x20000
    ds_write_b128 v6, v[188:191] offset:0
    ds_write_b128 v6, v[192:195] offset:1024
    ds_write_b128 v6, v[196:199] offset:2048
    ds_write_b128 v6, v[200:203] offset:3072
    ds_write_b128 v6, v[204:207] offset:4096
    ds_write_b128 v6, v[208:211] offset:5120
    s_mov_b64 exec, 0xffff
    ds_write_b64 v6, v[152:153] offset:5120
    s_mov_b64 exec, -1
    s_lshl_b32 s12, s6, 11
    v_add_u32 v6, s12, v5
    s_lshl_b32 s13, s11, 3
    s_add_u32 s13, s13, s8
    s_mul_i32 s13, s13, 3072
    s_lshl_b32 s12, s6, 10
    s_add_u32 s13, s13, s12
    s_waitcnt lgkmcnt(0)
    s_barrier
    ds_read_b128 v[128:131], v6 offset:0
    ds_read_b128 v[132:135], v6 offset:6144
    ds_read_b128 v[136:139], v6 offset:12288
    ds_read_b128 v[140:143], v6 offset:1024
    ds_read_b128 v[144:147], v6 offset:7168
    ds_read_b128 v[148:151], v6 offset:13312
    s_waitcnt lgkmcnt(3)
    v_pk_add_f32 v[128:129], v[128:129], v[132:133]
    v_pk_add_f32 v[130:131], v[130:131], v[134:135]
    v_pk_add_f32 v[128:129], v[128:129], v[136:137]
    v_pk_add_f32 v[130:131], v[130:131], v[138:139]
    s_waitcnt lgkmcnt(0)
    v_pk_add_f32 v[140:141], v[140:141], v[144:145]
    v_pk_add_f32 v[142:143], v[142:143], v[146:147]
    v_pk_add_f32 v[140:141], v[140:141], v[148:149]
    v_pk_add_f32 v[142:143], v[142:143], v[150:151]
    v_cvt_pk_bf16_f32 v128, v128, v129
    v_cvt_pk_bf16_f32 v129, v130, v131
    v_mov_b32 v130, v140
    v_mov_b32 v131, v141
    s_cmp_eq_u32 s6, 2
    s_cbranch_scc1 Lw2_64
    v_cvt_pk_bf16_f32 v130, v140, v141
    v_cvt_pk_bf16_f32 v131, v142, v143
Lw2_64:
    v_min_u32 v128, -2, v128
    v_min_u32 v129, -2, v129
    v_min_u32 v130, -2, v130
    v_min_u32 v131, -2, v131
    buffer_store_dwordx4 v[128:131], v5, s[40:43], s13 offen sc1
    s_mov_b32 s48, s34
    s_mov_b32 s49, s35
    s_mov_b32 s50, 1179648
    s_mov_b32 s51, 0x20000
    ds_read_b128 v[24:27], v246 offset:23552
    ds_read_b128 v[28:31], v246 offset:24576
    ds_read_b64 v[32:33], v247 offset:25600
    ds_read_b128 v[36:39], v246 offset:26112
    ds_read_b128 v[40:43], v246 offset:27136
    ds_read_b64 v[44:45], v247 offset:28160
    ds_read_b128 v[48:51], v246 offset:28672
    ds_read_b128 v[52:55], v246 offset:29696
    ds_read_b64 v[56:57], v247 offset:30720
    v_lshlrev_b32 v8, 2, v2
    v_lshl_add_u32 v8, v3, 7, v8
    v_add_u32 v8, 24576, v8
    v_lshlrev_b32 v10, 4, v2
    s_mul_i32 s13, s11, 24576
    s_add_u32 s13, s13, s12
    s_add_u32 s14, s13, 6144
    s_add_u32 s60, s13, 12288
    s_add_u32 s61, s13, 18432
    s_mov_b32 s62, 0x3f80
    s_mov_b32 s63, 0x3f800000
    s_mov_b32 s15, 0
Lxp_65:
    buffer_load_dwordx4 v[120:123], v5, s[40:43], s13 offen offset:0 sc1
    buffer_load_dwordx4 v[124:127], v5, s[40:43], s13 offen offset:3072 sc1
    buffer_load_dwordx4 v[128:131], v5, s[40:43], s14 offen offset:0 sc1
    buffer_load_dwordx4 v[132:135], v5, s[40:43], s14 offen offset:3072 sc1
    buffer_load_dwordx4 v[136:139], v5, s[40:43], s60 offen offset:0 sc1
    buffer_load_dwordx4 v[140:143], v5, s[40:43], s60 offen offset:3072 sc1
    buffer_load_dwordx4 v[144:147], v5, s[40:43], s61 offen offset:0 sc1
    buffer_load_dwordx4 v[148:151], v5, s[40:43], s61 offen offset:3072 sc1
    s_add_u32 s15, s15, 1
    s_waitcnt vmcnt(7)
    v_max_u32 v6, v120, v121
    v_max_u32 v7, v122, v123
    s_waitcnt vmcnt(6)
    v_max3_u32 v6, v6, v124, v125
    v_max3_u32 v7, v7, v126, v127
    s_waitcnt vmcnt(5)
    v_max3_u32 v6, v6, v128, v129
    v_max3_u32 v7, v7, v130, v131
    s_waitcnt vmcnt(4)
    v_max3_u32 v6, v6, v132, v133
    v_max3_u32 v7, v7, v134, v135
    s_waitcnt vmcnt(3)
    v_max3_u32 v6, v6, v136, v137
    v_max3_u32 v7, v7, v138, v139
    s_waitcnt vmcnt(2)
    v_max3_u32 v6, v6, v140, v141
    v_max3_u32 v7, v7, v142, v143
    s_waitcnt vmcnt(1)
    v_max3_u32 v6, v6, v144, v145
    v_max3_u32 v7, v7, v146, v147
    s_waitcnt vmcnt(0)
    v_max3_u32 v6, v6, v148, v149
    v_max3_u32 v7, v7, v150, v151
    v_max_u32 v6, v6, v7
    v_cmp_eq_u32 vcc, -1, v6
    s_cmp_ge_u32 s15, 32768
    s_cbranch_scc1 Lxp_65x
    s_nop 0
    s_cbranch_vccnz Lxp_65
Lxp_65x:
    v_dot2_f32_bf16 v152, v120, s62, 0
    v_dot2_f32_bf16 v153, v120, s63, 0
    v_dot2_f32_bf16 v154, v121, s62, 0
    v_dot2_f32_bf16 v155, v121, s63, 0
    v_dot2_f32_bf16 v152, v124, s62, v152
    v_dot2_f32_bf16 v153, v124, s63, v153
    v_dot2_f32_bf16 v154, v125, s62, v154
    v_dot2_f32_bf16 v155, v125, s63, v155
    v_dot2_f32_bf16 v152, v128, s62, v152
    v_dot2_f32_bf16 v153, v128, s63, v153
    v_dot2_f32_bf16 v154, v129, s62, v154
    v_dot2_f32_bf16 v155, v129, s63, v155
    v_dot2_f32_bf16 v152, v132, s62, v152
    v_dot2_f32_bf16 v153, v132, s63, v153
    v_dot2_f32_bf16 v154, v133, s62, v154
    v_dot2_f32_bf16 v155, v133, s63, v155
    v_dot2_f32_bf16 v152, v136, s62, v152
    v_dot2_f32_bf16 v153, v136, s63, v153
    v_dot2_f32_bf16 v154, v137, s62, v154
    v_dot2_f32_bf16 v155, v137, s63, v155
    v_dot2_f32_bf16 v152, v140, s62, v152
    v_dot2_f32_bf16 v153, v140, s63, v153
    v_dot2_f32_bf16 v154, v141, s62, v154
    v_dot2_f32_bf16 v155, v141, s63, v155
    v_dot2_f32_bf16 v152, v144, s62, v152
    v_dot2_f32_bf16 v153, v144, s63, v153
    v_dot2_f32_bf16 v154, v145, s62, v154
    v_dot2_f32_bf16 v155, v145, s63, v155
    v_dot2_f32_bf16 v152, v148, s62, v152
    v_dot2_f32_bf16 v153, v148, s63, v153
    v_dot2_f32_bf16 v154, v149, s62, v154
    v_dot2_f32_bf16 v155, v149, s63, v155
    s_cmp_eq_u32 s6, 2
    s_cbranch_scc1 Lw2_66
    v_dot2_f32_bf16 v156, v122, s62, 0
    v_dot2_f32_bf16 v157, v122, s63, 0
    v_dot2_f32_bf16 v158, v123, s62, 0
    v_dot2_f32_bf16 v159, v123, s63, 0
    v_dot2_f32_bf16 v156, v126, s62, v156
    v_dot2_f32_bf16 v157, v126, s63, v157
    v_dot2_f32_bf16 v158, v127, s62, v158
    v_dot2_f32_bf16 v159, v127, s63, v159
    v_dot2_f32_bf16 v156, v130, s62, v156
    v_dot2_f32_bf16 v157, v130, s63, v157
    v_dot2_f32_bf16 v158, v131, s62, v158
    v_dot2_f32_bf16 v159, v131, s63, v159
    v_dot2_f32_bf16 v156, v134, s62, v156
    v_dot2_f32_bf16 v157, v134, s63, v157
    v_dot2_f32_bf16 v158, v135, s62, v158
    v_dot2_f32_bf16 v159, v135, s63, v159
    v_dot2_f32_bf16 v156, v138, s62, v156
    v_dot2_f32_bf16 v157, v138, s63, v157
    v_dot2_f32_bf16 v158, v139, s62, v158
    v_dot2_f32_bf16 v159, v139, s63, v159
    v_dot2_f32_bf16 v156, v142, s62, v156
    v_dot2_f32_bf16 v157, v142, s63, v157
    v_dot2_f32_bf16 v158, v143, s62, v158
    v_dot2_f32_bf16 v159, v143, s63, v159
    v_dot2_f32_bf16 v156, v146, s62, v156
    v_dot2_f32_bf16 v157, v146, s63, v157
    v_dot2_f32_bf16 v158, v147, s62, v158
    v_dot2_f32_bf16 v159, v147, s63, v159
    v_dot2_f32_bf16 v156, v150, s62, v156
    v_dot2_f32_bf16 v157, v150, s63, v157
    v_dot2_f32_bf16 v158, v151, s62, v158
    v_dot2_f32_bf16 v159, v151, s63, v159
    s_branch Lw3_67
Lw2_66:
    v_pk_add_f32 v[156:157], v[122:123], v[126:127]
    v_pk_add_f32 v[158:159], v[130:131], v[134:135]
    v_pk_add_f32 v[156:157], v[156:157], v[138:139]
    v_pk_add_f32 v[158:159], v[158:159], v[142:143]
    v_pk_add_f32 v[156:157], v[156:157], v[146:147]
    v_pk_add_f32 v[158:159], v[158:159], v[150:151]
    v_pk_add_f32 v[156:157], v[156:157], v[158:159]
    ds_write2_b32 v8, v156, v157 offset0:0 offset1:16
    v_mul_f32 v158, 0x3a638e39, v156
    v_mul_f32 v159, 0x3a638e39, v157
    v_fma_f32 v159, -v158, v158, v159
    v_max_f32 v159, 0, v159
    v_add_f32 v159, 0x3727c5ac, v159
    v_rsq_f32 v159, v159
    s_nop 0
    v_mul_f32 v159, 0x3d2e1a93, v159
Lw3_67:
    s_lshl_b32 s12, s6, 11
    v_add_u32 v6, s12, v5
    s_nop 1
    ds_write_b128 v6, v[152:155] offset:18432
    ds_write_b128 v6, v[156:159] offset:19456
    s_waitcnt lgkmcnt(0)
    s_barrier
    ds_read_b64 v[204:205], v10 offset:23560
    ds_read_b128 v[184:187], v5 offset:18432
    ds_read_b128 v[60:63], v11 offset:24704
    ds_read_b128 v[188:191], v5 offset:19456
    ds_read_b128 v[64:67], v11 offset:24768
    ds_read_b128 v[192:195], v5 offset:20480
    ds_read_b128 v[68:71], v11 offset:24832
    ds_read_b128 v[196:199], v5 offset:21504
    ds_read_b128 v[72:75], v11 offset:24896
    ds_read_b128 v[200:203], v5 offset:22528
    ds_read_b128 v[76:79], v11 offset:24960
    v_cmp_le_u32 vcc, 48, v1
    v_mov_b32 v8, 0xf149f2ca
    s_waitcnt lgkmcnt(8)
    v_fma_f32 v184, -v204, v60, v184
    v_fma_f32 v185, -v204, v61, v185
    v_fma_f32 v186, -v204, v62, v186
    v_fma_f32 v187, -v204, v63, v187
    s_waitcnt lgkmcnt(6)
    v_fma_f32 v188, -v204, v64, v188
    v_fma_f32 v189, -v204, v65, v189
    v_fma_f32 v190, -v204, v66, v190
    v_fma_f32 v191, -v204, v67, v191
    s_waitcnt lgkmcnt(4)
    v_fma_f32 v192, -v204, v68, v192
    v_fma_f32 v193, -v204, v69, v193
    v_fma_f32 v194, -v204, v70, v194
    v_fma_f32 v195, -v204, v71, v195
    s_waitcnt lgkmcnt(2)
    v_fma_f32 v196, -v204, v72, v196
    v_fma_f32 v197, -v204, v73, v197
    v_fma_f32 v198, -v204, v74, v198
    v_fma_f32 v199, -v204, v75, v199
    s_waitcnt lgkmcnt(0)
    v_fma_f32 v200, -v204, v76, v200
    v_fma_f32 v201, -v204, v77, v201
    v_fma_f32 v202, -v204, v78, v202
    v_fma_f32 v203, -v204, v79, v203
    v_cndmask_b32 v201, v201, v8, vcc
    v_cndmask_b32 v202, v202, v8, vcc
    v_cndmask_b32 v203, v203, v8, vcc
    v_max3_f32 v7, v184, v185, v186
    v_max3_f32 v8, v187, v188, v189
    v_max3_f32 v7, v7, v190, v191
    v_max3_f32 v8, v8, v192, v193
    v_max3_f32 v7, v7, v194, v195
    v_max3_f32 v8, v8, v196, v197
    v_max3_f32 v7, v7, v198, v199
    v_max3_f32 v8, v8, v200, v201
    v_max3_f32 v7, v7, v202, v203
    v_max_f32 v7, v7, v8
    v_mov_b32 v6, v7
    s_nop 1
    v_permlane16_swap_b32 v7, v6
    s_nop 0
    v_max_f32 v7, v7, v6
    v_mov_b32 v6, v7
    s_nop 1
    v_permlane32_swap_b32 v7, v6
    s_nop 0
    v_max_f32 v7, v7, v6
    v_mul_f32 v7, v7, v205
    v_fma_f32 v184, v184, v205, -v7
    v_fma_f32 v185, v185, v205, -v7
    v_fma_f32 v186, v186, v205, -v7
    v_fma_f32 v187, v187, v205, -v7
    v_fma_f32 v188, v188, v205, -v7
    v_fma_f32 v189, v189, v205, -v7
    v_fma_f32 v190, v190, v205, -v7
    v_fma_f32 v191, v191, v205, -v7
    v_fma_f32 v192, v192, v205, -v7
    v_fma_f32 v193, v193, v205, -v7
    v_fma_f32 v194, v194, v205, -v7
    v_fma_f32 v195, v195, v205, -v7
    v_fma_f32 v196, v196, v205, -v7
    v_fma_f32 v197, v197, v205, -v7
    v_fma_f32 v198, v198, v205, -v7
    v_fma_f32 v199, v199, v205, -v7
    v_fma_f32 v200, v200, v205, -v7
    v_fma_f32 v201, v201, v205, -v7
    v_fma_f32 v202, v202, v205, -v7
    v_fma_f32 v203, v203, v205, -v7
    v_exp_f32 v184, v184
    v_exp_f32 v185, v185
    v_exp_f32 v186, v186
    v_exp_f32 v187, v187
    v_exp_f32 v188, v188
    v_exp_f32 v189, v189
    v_exp_f32 v190, v190
    v_exp_f32 v191, v191
    v_exp_f32 v192, v192
    v_exp_f32 v193, v193
    v_exp_f32 v194, v194
    v_exp_f32 v195, v195
    v_exp_f32 v196, v196
    v_exp_f32 v197, v197
    v_exp_f32 v198, v198
    v_exp_f32 v199, v199
    v_exp_f32 v200, v200
    v_exp_f32 v201, v201
    v_exp_f32 v202, v202
    v_exp_f32 v203, v203
    v_cvt_pk_bf16_f32 v208, v184, v185
    v_cvt_pk_bf16_f32 v209, v186, v187
    v_cvt_pk_bf16_f32 v210, v188, v189
    v_cvt_pk_bf16_f32 v211, v190, v191
    v_cvt_pk_bf16_f32 v212, v192, v193
    v_cvt_pk_bf16_f32 v213, v194, v195
    v_cvt_pk_bf16_f32 v214, v196, v197
    v_cvt_pk_bf16_f32 v215, v198, v199
    v_cvt_pk_bf16_f32 v216, v200, v201
    v_cvt_pk_bf16_f32 v217, v202, v203
    v_pk_add_f32 v[184:185], v[184:185], v[186:187]
    v_pk_add_f32 v[188:189], v[188:189], v[190:191]
    v_mfma_f32_16x16x32_bf16 v[80:83], v[24:27], v[208:211], 0
    v_pk_add_f32 v[184:185], v[184:185], v[192:193]
    v_mfma_f32_16x16x32_bf16 v[84:87], v[36:39], v[208:211], 0
    v_pk_add_f32 v[188:189], v[188:189], v[194:195]
    v_mfma_f32_16x16x32_bf16 v[88:91], v[48:51], v[208:211], 0
    v_pk_add_f32 v[184:185], v[184:185], v[196:197]
    v_mfma_f32_16x16x32_bf16 v[80:83], v[28:31], v[212:215], v[80:83]
    v_pk_add_f32 v[188:189], v[188:189], v[198:199]
    v_mfma_f32_16x16x32_bf16 v[84:87], v[40:43], v[212:215], v[84:87]
    v_pk_add_f32 v[184:185], v[184:185], v[200:201]
    v_mfma_f32_16x16x32_bf16 v[88:91], v[52:55], v[212:215], v[88:91]
    v_pk_add_f32 v[188:189], v[188:189], v[202:203]
    v_mfma_f32_16x16x16_bf16 v[92:95], v[32:33], v[216:217], 0
    v_pk_add_f32 v[184:185], v[184:185], v[188:189]
    v_mfma_f32_16x16x16_bf16 v[96:99], v[44:45], v[216:217], 0
    v_add_f32 v7, v184, v185
    v_mfma_f32_16x16x16_bf16 v[100:103], v[56:57], v[216:217], 0
    v_mov_b32 v6, v7
    s_nop 1
    v_permlane16_swap_b32 v7, v6
    s_nop 0
    v_add_f32 v7, v7, v6
    v_mov_b32 v6, v7
    s_nop 1
    v_permlane32_swap_b32 v7, v6
    s_nop 0
    v_add_f32 v7, v7, v6
    v_rcp_f32 v7, v7
    v_pk_add_f32 v[80:81], v[80:81], v[92:93]
    v_pk_add_f32 v[82:83], v[82:83], v[94:95]
    v_pk_add_f32 v[84:85], v[84:85], v[96:97]
    v_pk_add_f32 v[86:87], v[86:87], v[98:99]
    v_pk_add_f32 v[88:89], v[88:89], v[100:101]
    v_pk_add_f32 v[90:91], v[90:91], v[102:103]
    v_fmac_f32 v12, v7, v80
    v_fmac_f32 v13, v7, v81
    v_fmac_f32 v14, v7, v82
    v_fmac_f32 v15, v7, v83
    v_cvt_pk_bf16_f32 v12, v12, v13
    v_cvt_pk_bf16_f32 v13, v14, v15
    buffer_store_dwordx2 v[12:13], v9, s[48:51], 0 offen offset:0
    v_fmac_f32 v16, v7, v84
    v_fmac_f32 v17, v7, v85
    v_fmac_f32 v18, v7, v86
    v_fmac_f32 v19, v7, v87
    v_cvt_pk_bf16_f32 v16, v16, v17
    v_cvt_pk_bf16_f32 v17, v18, v19
    buffer_store_dwordx2 v[16:17], v9, s[48:51], 0 offen offset:32
    v_fmac_f32 v20, v7, v88
    v_fmac_f32 v21, v7, v89
    v_fmac_f32 v22, v7, v90
    v_fmac_f32 v23, v7, v91
    v_cvt_pk_bf16_f32 v20, v20, v21
    v_cvt_pk_bf16_f32 v21, v22, v23
    buffer_store_dwordx2 v[20:21], v9, s[48:51], 0 offen offset:64
standalone__pixart__diffusion_kernel_end:
    s_endpgm
k4_poll:
    s_and_b32 s8, s4, 3
    s_lshl_b32 s8, s8, 1
    s_and_b32 s12, s5, 1
    s_add_u32 s8, s8, s12
    s_mul_i32 s11, s8, 9
    s_and_b32 s8, s11, -4
    v_min_u32 v6, 11, v1
    v_add_u32 v6, s8, v6
    v_mul_u32_u24 v7, 57, v6
    v_lshrrev_b32 v7, 10, v7
    v_mul_u32_u24 v7, 14, v7
    v_add_lshl_u32 v6, v6, v7, 2
    s_lshr_b32 s9, s5, 4
    s_lshl_b32 s9, s9, 8
    s_bfe_u32 s10, s5, 0x10003
    s_lshl_b32 s10, s10, 3
    s_add_u32 s9, s9, s10
    s_add_u32 s9, s9, 72
    v_bfe_u32 v7, v1, 1, 1
    v_and_b32 v8, 1, v1
    v_lshlrev_b32 v8, 2, v8
    v_lshl_add_u32 v7, v7, 7, v8
    v_add_u32 v7, s9, v7
    v_cmp_le_u32 vcc, 12, v1
    v_mov_b32 v8, 88
    v_cndmask_b32 v6, v6, v7, vcc
    v_cmp_le_u32 vcc, 16, v1
    s_nop 0
    v_cndmask_b32 v6, v6, v8, vcc
    s_add_u32 s12, s101, 1316
    s_add_u32 s13, s101, 1280
    v_lshlrev_b32 v7, 3, v1
    s_add_u32 s40, s38, 5505024
    s_addc_u32 s41, s39, 0
    s_mov_b32 s42, 368640
    s_mov_b32 s43, 0x20000
    s_add_u32 s44, s38, 5898240
    s_addc_u32 s45, s39, 0
    s_mov_b32 s46, 368640
    s_mov_b32 s47, 0x20000
    s_lshr_b32 s9, s4, 2
    s_mul_i32 s9, s9, 184320
    s_mul_i32 s10, s11, 2560
    s_add_u32 s9, s9, s10
    s_lshr_b32 s8, s8, 2
    v_min_u32 v9, 2, v1
    v_add_u32 v9, s8, v9
    v_cmp_le_u32 vcc, 9, v9
    v_lshlrev_b32 v9, 2, v9
    v_add_u32 v10, 92, v9
    v_cndmask_b32 v10, v9, v10, vcc
    v_min_u32 v9, 5, v1
    v_lshlrev_b32 v9, 7, v9
    v_subrev_u32 v9, 132, v9
    v_cmp_gt_u32 vcc, 3, v1
    s_add_u32 s14, s13, 256
    v_cndmask_b32 v9, v9, v10, vcc
    buffer_load_dword v8, v6, s[56:59], s12 offen sc1
    s_mov_b32 s68, 0
    s_branch Lfp_68e
Lfp_68:
    buffer_load_dword v8, v6, s[56:59], s12 offen sc1
Lfp_68e:
    s_waitcnt vmcnt(0)
    v_cmp_ne_u32 vcc, s3, v8
    s_add_u32 s68, s68, 1
    s_cmp_ge_u32 s68, 32768
    s_cbranch_scc1 Lfp_68x
    s_cbranch_vccnz Lfp_68
Lfp_68x:
    s_barrier
    buffer_load_dword v12, v9, s[56:59], s13 offen sc1
    s_barrier
    s_mov_b32 s68, 0
    s_branch Lfp_69e
Lfp_69:
    buffer_load_dword v12, v9, s[56:59], s13 offen sc1
Lfp_69e:
    s_waitcnt vmcnt(0)
    v_cmp_ne_u32 vcc, s3, v12
    s_add_u32 s68, s68, 1
    s_cmp_ge_u32 s68, 32768
    s_cbranch_scc1 Lfp_69x
    s_cbranch_vccnz Lfp_69
Lfp_69x:
    buffer_load_dword v16, v10, s[56:59], s14 offen sc1
    s_mov_b32 m0, 36864
    s_add_u32 s10, s9, 0
    buffer_load_dwordx4 v5, s[40:43], s10 offen offset:0 lds
    buffer_load_dwordx4 v5, s[40:43], s10 offen offset:1024 lds
    buffer_load_dwordx4 v5, s[40:43], s10 offen offset:2048 lds
    buffer_load_dwordx4 v5, s[40:43], s10 offen offset:3072 lds
    s_mov_b32 m0, 40960
    s_add_u32 s10, s9, 4096
    buffer_load_dwordx4 v5, s[40:43], s10 offen offset:0 lds
    buffer_load_dwordx4 v5, s[40:43], s10 offen offset:1024 lds
    buffer_load_dwordx4 v5, s[40:43], s10 offen offset:2048 lds
    buffer_load_dwordx4 v5, s[40:43], s10 offen offset:3072 lds
    s_mov_b32 m0, 45056
    s_add_u32 s10, s9, 8192
    buffer_load_dwordx4 v5, s[40:43], s10 offen offset:0 lds
    buffer_load_dwordx4 v5, s[40:43], s10 offen offset:1024 lds
    buffer_load_dwordx4 v5, s[40:43], s10 offen offset:2048 lds
    buffer_load_dwordx4 v5, s[40:43], s10 offen offset:3072 lds
    s_mov_b32 m0, 49152
    s_add_u32 s10, s9, 12288
    buffer_load_dwordx4 v5, s[40:43], s10 offen offset:0 lds
    buffer_load_dwordx4 v5, s[40:43], s10 offen offset:1024 lds
    buffer_load_dwordx4 v5, s[40:43], s10 offen offset:2048 lds
    buffer_load_dwordx4 v5, s[40:43], s10 offen offset:3072 lds
    s_mov_b32 m0, 53248
    s_add_u32 s10, s9, 16384
    buffer_load_dwordx4 v5, s[40:43], s10 offen offset:0 lds
    buffer_load_dwordx4 v5, s[40:43], s10 offen offset:1024 lds
    buffer_load_dwordx4 v5, s[40:43], s10 offen offset:2048 lds
    buffer_load_dwordx4 v5, s[40:43], s10 offen offset:3072 lds
    s_mov_b32 m0, 57344
    s_add_u32 s10, s9, 20480
    buffer_load_dwordx4 v5, s[40:43], s10 offen offset:0 lds
    buffer_load_dwordx4 v5, s[40:43], s10 offen offset:1024 lds
    s_mov_b32 exec_hi, 0
    buffer_load_dwordx4 v5, s[40:43], s10 offen offset:2048 lds
    s_mov_b32 exec_hi, -1
    s_waitcnt vmcnt(23)
    v_cmp_ne_u32 vcc, s3, v16
    s_nop 4
    s_cbranch_vccz Lbv_70
    s_waitcnt vmcnt(0)
    s_barrier
    buffer_load_dword v16, v10, s[56:59], s14 offen sc1
    s_mov_b32 s68, 0
    s_branch Lfp_71e
Lfp_71:
    buffer_load_dword v16, v10, s[56:59], s14 offen sc1
Lfp_71e:
    s_waitcnt vmcnt(0)
    v_cmp_ne_u32 vcc, s3, v16
    s_add_u32 s68, s68, 1
    s_cmp_ge_u32 s68, 32768
    s_cbranch_scc1 Lfp_71x
    s_cbranch_vccnz Lfp_71
Lfp_71x:
    s_mov_b32 m0, 60416
    s_add_u32 s10, s9, 0
    buffer_load_dwordx4 v5, s[44:47], s10 offen offset:0 lds
    buffer_load_dwordx4 v5, s[44:47], s10 offen offset:1024 lds
    buffer_load_dwordx4 v5, s[44:47], s10 offen offset:2048 lds
    buffer_load_dwordx4 v5, s[44:47], s10 offen offset:3072 lds
    s_mov_b32 m0, 64512
    s_add_u32 s10, s9, 4096
    buffer_load_dwordx4 v5, s[44:47], s10 offen offset:0 lds
    buffer_load_dwordx4 v5, s[44:47], s10 offen offset:1024 lds
    buffer_load_dwordx4 v5, s[44:47], s10 offen offset:2048 lds
    buffer_load_dwordx4 v5, s[44:47], s10 offen offset:3072 lds
    s_mov_b32 m0, 68608
    s_add_u32 s10, s9, 8192
    buffer_load_dwordx4 v5, s[44:47], s10 offen offset:0 lds
    buffer_load_dwordx4 v5, s[44:47], s10 offen offset:1024 lds
    buffer_load_dwordx4 v5, s[44:47], s10 offen offset:2048 lds
    buffer_load_dwordx4 v5, s[44:47], s10 offen offset:3072 lds
    s_mov_b32 m0, 72704
    s_add_u32 s10, s9, 12288
    buffer_load_dwordx4 v5, s[44:47], s10 offen offset:0 lds
    buffer_load_dwordx4 v5, s[44:47], s10 offen offset:1024 lds
    buffer_load_dwordx4 v5, s[44:47], s10 offen offset:2048 lds
    buffer_load_dwordx4 v5, s[44:47], s10 offen offset:3072 lds
    s_mov_b32 m0, 76800
    s_add_u32 s10, s9, 16384
    buffer_load_dwordx4 v5, s[44:47], s10 offen offset:0 lds
    buffer_load_dwordx4 v5, s[44:47], s10 offen offset:1024 lds
    buffer_load_dwordx4 v5, s[44:47], s10 offen offset:2048 lds
    buffer_load_dwordx4 v5, s[44:47], s10 offen offset:3072 lds
    s_mov_b32 m0, 80896
    s_add_u32 s10, s9, 20480
    buffer_load_dwordx4 v5, s[44:47], s10 offen offset:0 lds
    buffer_load_dwordx4 v5, s[44:47], s10 offen offset:1024 lds
    s_mov_b32 exec_hi, 0
    buffer_load_dwordx4 v5, s[44:47], s10 offen offset:2048 lds
    s_mov_b32 exec_hi, -1
    s_branch Lbv_70x
Lbv_70:
    s_mov_b32 m0, 60416
    s_add_u32 s10, s9, 0
    buffer_load_dwordx4 v5, s[44:47], s10 offen offset:0 lds
    buffer_load_dwordx4 v5, s[44:47], s10 offen offset:1024 lds
    buffer_load_dwordx4 v5, s[44:47], s10 offen offset:2048 lds
    buffer_load_dwordx4 v5, s[44:47], s10 offen offset:3072 lds
    s_mov_b32 m0, 64512
    s_add_u32 s10, s9, 4096
    buffer_load_dwordx4 v5, s[44:47], s10 offen offset:0 lds
    buffer_load_dwordx4 v5, s[44:47], s10 offen offset:1024 lds
    buffer_load_dwordx4 v5, s[44:47], s10 offen offset:2048 lds
    buffer_load_dwordx4 v5, s[44:47], s10 offen offset:3072 lds
    s_mov_b32 m0, 68608
    s_add_u32 s10, s9, 8192
    buffer_load_dwordx4 v5, s[44:47], s10 offen offset:0 lds
    buffer_load_dwordx4 v5, s[44:47], s10 offen offset:1024 lds
    buffer_load_dwordx4 v5, s[44:47], s10 offen offset:2048 lds
    buffer_load_dwordx4 v5, s[44:47], s10 offen offset:3072 lds
    s_mov_b32 m0, 72704
    s_add_u32 s10, s9, 12288
    buffer_load_dwordx4 v5, s[44:47], s10 offen offset:0 lds
    buffer_load_dwordx4 v5, s[44:47], s10 offen offset:1024 lds
    buffer_load_dwordx4 v5, s[44:47], s10 offen offset:2048 lds
    buffer_load_dwordx4 v5, s[44:47], s10 offen offset:3072 lds
    s_mov_b32 m0, 76800
    s_add_u32 s10, s9, 16384
    buffer_load_dwordx4 v5, s[44:47], s10 offen offset:0 lds
    buffer_load_dwordx4 v5, s[44:47], s10 offen offset:1024 lds
    buffer_load_dwordx4 v5, s[44:47], s10 offen offset:2048 lds
    buffer_load_dwordx4 v5, s[44:47], s10 offen offset:3072 lds
    s_mov_b32 m0, 80896
    s_add_u32 s10, s9, 20480
    buffer_load_dwordx4 v5, s[44:47], s10 offen offset:0 lds
    buffer_load_dwordx4 v5, s[44:47], s10 offen offset:1024 lds
    s_mov_b32 exec_hi, 0
    buffer_load_dwordx4 v5, s[44:47], s10 offen offset:2048 lds
    s_mov_b32 exec_hi, -1
    s_waitcnt vmcnt(23)
    s_barrier
Lbv_70x:
    s_waitcnt vmcnt(0)
    s_cmp_lg_u32 s2, 0
    s_cbranch_scc1 k4_pe
    s_barrier
    s_barrier
    buffer_load_dwordx2 v[12:13], v7, s[56:59], s13 offen sc1
    s_mov_b32 s68, 0
    s_branch Lfp_72e
Lfp_72:
    buffer_load_dwordx2 v[12:13], v7, s[56:59], s13 offen sc1
Lfp_72e:
    s_waitcnt vmcnt(0)
    v_xor_b32 v12, s3, v12
    v_xor_b32 v13, s3, v13
    v_or_b32 v12, v12, v13
    v_cmp_ne_u32 vcc, 0, v12
    s_add_u32 s68, s68, 1
    s_cmp_ge_u32 s68, 32768
    s_cbranch_scc1 Lfp_72x
    s_cbranch_vccnz Lfp_72
Lfp_72x:
    s_add_u32 s13, s13, 73728
    buffer_load_dwordx2 v[12:13], v7, s[56:59], s13 offen sc1
    s_mov_b32 s68, 0
    s_branch Lfp_73e
Lfp_73:
    buffer_load_dwordx2 v[12:13], v7, s[56:59], s13 offen sc1
Lfp_73e:
    s_waitcnt vmcnt(0)
    v_xor_b32 v12, s3, v12
    v_xor_b32 v13, s3, v13
    v_or_b32 v12, v12, v13
    v_cmp_ne_u32 vcc, 0, v12
    s_add_u32 s68, s68, 1
    s_cmp_ge_u32 s68, 32768
    s_cbranch_scc1 Lfp_73x
    s_cbranch_vccnz Lfp_73
Lfp_73x:
    s_add_u32 s48, s38, 7790592
    s_addc_u32 s49, s39, 0
    s_mov_b32 s50, 64
    s_mov_b32 s51, 0x20000
    v_mov_b32 v6, 0
    v_mov_b32 v8, s3
    s_mov_b64 exec, 1
    buffer_store_dword v8, v6, s[48:51], 0 offen sc1
k4_pe:
    s_endpgm
k4_last:
    .section .rodata,"a"
    .p2align 6
    .amdhsa_kernel standalone__pixart__diffusion_kernel
    .amdhsa_next_free_vgpr 256
    .amdhsa_next_free_sgpr 102
    .amdhsa_accum_offset 256
    .amdhsa_group_segment_fixed_size 0
    .amdhsa_kernarg_size 96
    .amdhsa_user_sgpr_count 2
    .amdhsa_user_sgpr_kernarg_segment_ptr 1
    .amdhsa_system_sgpr_workgroup_id_x 1
    .end_amdhsa_kernel
    .text
```
